```python
import torch

def _softmax(x, axis=-1):
    return torch.softmax(x, dim=axis)
def _gelu(x):
    return torch.nn.functional.gelu(x, approximate="tanh")
def _silu(x):
    return torch.nn.functional.silu(x)
def _sigmoid(x):
    return torch.sigmoid(x)
def _layernorm(x, axis=-1, eps=1e-5):
    m = x.mean(dim=axis, keepdim=True)
    v = x.var(dim=axis, keepdim=True, unbiased=False)
    return (x - m) / torch.sqrt(v + eps)
def _scatter_add(tgt, idx, src, axis=0):
    return tgt.clone().index_add_(axis, idx, src)
def _segment_sum(src, seg, n):
    out = torch.zeros((n,) + src.shape[1:], dtype=src.dtype)
    return out.index_add_(0, seg, src)
def _pad(x, pw):
    flat = tuple(v for pair in reversed(pw) for v in pair)
    return torch.nn.functional.pad(x, flat)

kernel_name = 'parallel_sum__ssm_conv_h3__geglu_ffn__prompt'

def setup_inputs():

    _w = (lambda a: (lambda t: t.to(torch.bfloat16) if t.is_floating_point() else t)(torch.as_tensor(a)))
    def _A_setup():
        B, S, D = 1, 2048, 512
        ks = 4
        return {
            "q": _w((lambda *s: torch.randn(*s, dtype=torch.bfloat16) * 0.05)(B, S, D)),
            "k": _w((lambda *s: torch.randn(*s, dtype=torch.bfloat16) * 0.8)(B, S, D)),
            "v": _w((lambda *s: torch.randn(*s, dtype=torch.bfloat16) * 0.8)(B, S, D)),
            "shift_k": _w((lambda *s: torch.randn(*s, dtype=torch.bfloat16) * 0.8)(D, ks) * 0.5),
            "ssm_k": _w((lambda *s: torch.randn(*s, dtype=torch.bfloat16) * 0.8)(D, S) * (1.0 / S ** 0.5)),
            "ssm_D": _w((lambda *s: torch.randn(*s, dtype=torch.bfloat16) * 0.8)(D)),
        }
    _A_in = _A_setup()

    def _B_setup():
        B, S, D, F = 1, 2048, 512, 1376
        return {
            "x": _w((lambda *s: torch.randn(*s, dtype=torch.bfloat16) * 0.05)(B, S, D)),
            "w_gate": _w((lambda *s: torch.randn(*s, dtype=torch.bfloat16) * 0.05)(D, F)),
            "w_up": _w((lambda *s: torch.randn(*s, dtype=torch.bfloat16) * 0.05)(D, F)),
            "w_down": _w((lambda *s: torch.randn(*s, dtype=torch.bfloat16) * 0.05)(F, D)),
        }
    _B_in = _B_setup()

    return {
        "A_q": _A_in["q"],
        "A_k": _A_in["k"],
        "A_v": _A_in["v"],
        "A_shift_k": _A_in["shift_k"],
        "A_ssm_k": _A_in["ssm_k"],
        "A_ssm_D": _A_in["ssm_D"],
        "B_x": _B_in["x"],
        "B_w_gate": _B_in["w_gate"],
        "B_w_up": _B_in["w_up"],
        "B_w_down": _B_in["w_down"],
    }

def reference(A_q, A_k, A_v, A_shift_k, A_ssm_k, A_ssm_D, B_x, B_w_gate, B_w_up, B_w_down):
    def _A_ref(q, k, v, shift_k, ssm_k, ssm_D):
        B, S, D = q.shape
        ks = shift_k.shape[-1]
        k_pad = _pad(k, ((0, 0), (ks - 1, 0), (0, 0)))
        k_shift = torch.zeros_like(k)
        for t in range(ks):
            k_shift = k_shift + k_pad[:, t:t + S, :] * shift_k[:, ks - 1 - t][None, None, :]
        kv = k_shift * v
        L = 2 * S
        kv_pad = _pad(kv, ((0, 0), (0, S), (0, 0)))
        kf_pad = _pad(ssm_k, ((0, 0), (0, S)))
        kv_f = (lambda x, axes=(-2,-1): torch.fft.rfft2(x.float(), dim=axes))(kv_pad[:, None, :, :], axes=(1, 2))
        kf_f = (lambda x, axes=(-2,-1): torch.fft.rfft2(x.float(), dim=axes))(kf_pad[:, None, :], axes=(1, 2))
        kf_f = (lambda x, *d: x.permute(*d))(kf_f, 1, 2, 0)
        y_f = kv_f * kf_f[None, :, :, :]
        y = (lambda x, s, axes=(-2,-1): torch.fft.irfft2(x, s=s, dim=axes).to(torch.bfloat16))(y_f, (1, L), axes=(1, 2))[:, 0, :S, :]
        y = y + kv * ssm_D[None, None, :]
        return q * y

    def _B_ref(x, w_gate, w_up, w_down):
        return (_gelu(x @ w_gate) * (x @ w_up)) @ w_down

    x = A_q
    xn = _layernorm(x, axis=-1)
    return x + _A_ref(xn, A_k, A_v, A_shift_k, A_ssm_k, A_ssm_D) + _B_ref(xn, B_w_gate, B_w_up, B_w_down)
```

```asm
; @launch grid=(256,1,1) block=(512,1,1) lds=163840
.amdgcn_target "amdgcn-amd-amdhsa--gfx950"
.text
.globl parallel_sum__ssm_conv_h3__geglu_ffn__prompt_kernel
.p2align 8
.type parallel_sum__ssm_conv_h3__geglu_ffn__prompt_kernel,@function
parallel_sum__ssm_conv_h3__geglu_ffn__prompt_kernel:
    s_getpc_b64 s[14:15]
L_code_start:
    s_cmp_ge_u32 s2, 256
    s_cbranch_scc1 L_end
    s_load_dwordx16 s[16:31], s[0:1], 0
    s_load_dwordx8 s[32:39], s[0:1], 64
    s_load_dwordx2 s[40:41], s[0:1], 96
    s_mov_b32 s72, s14
    s_mov_b32 s73, s15
    s_mov_b32 s74, L_code_end-L_code_start
    s_mov_b32 s75, 0x00020000
    s_lshl_b32 s42, s2, 10
    s_and_b32 s42, s42, 24576
    v_lshlrev_b32 v7, 4, v0
    buffer_load_dwordx4 v[128:131], v7, s[72:75], s42 offen
    v_lshrrev_b32 v1, 6, v0
    v_and_b32 v0, 63, v0
    s_lshr_b32 s5, s2, 3
    v_readfirstlane_b32 s3, v1
    s_and_b32 s4, s2, 7
    s_lshr_b32 s12, s5, 2
    s_and_b32 s13, s5, 3
    s_lshr_b32 s6, s4, 2
    s_lshl3_add_u32 s6, s6, s12
    s_and_b32 s7, s4, 3
    s_lshl2_add_u32 s7, s7, s13
    s_and_b32 s11, s3, 3
    s_add_u32 s10, s12, s13
    s_lshl_b32 s10, s10, 1
    s_cmp_lt_u32 s3, 4
    s_cbranch_scc1 L_groupA
    s_branch L_groupB
L_groupA:
    v_lshrrev_b32 v8, 3, v0
    v_and_b32 v9, 7, v0
    v_lshrrev_b32 v10, 4, v0
    v_xor_b32 v11, v9, v10
    v_lshlrev_b32 v11, 4, v11
    v_lshl_add_u32 v2, v8, 10, v11
    v_xor_b32 v11, 64, v11
    v_lshl_add_u32 v3, v8, 10, v11
    v_add_u32 v3, 8192, v3
    s_lshl2_add_u32 s48, s6, s11
    s_lshl_b32 s48, s48, 15
    s_lshl_b32 s50, s11, 12
    s_cmp_eq_u32 s7, 15
    s_cselect_b32 s46, 0, 0x200000
    s_mov_b32 s47, 0x00020000
    s_add_u32 s12, s10, 0
    s_and_b32 s12, s12, 7
    s_lshl_b32 s74, s12, 7
    s_add_u32 s74, s74, s48
    s_cmp_eq_u32 s7, 15
    s_cbranch_scc1 L_idleA0
    s_waitcnt lgkmcnt(0)
    s_mov_b32 s44, s16
    s_mov_b32 s45, s17
    s_add_u32 m0, s50, 0
    s_nop 0
    buffer_load_dwordx4 v2, s[44:47], s74 offen lds
    s_add_u32 m0, s50, 1024
    s_nop 0
    buffer_load_dwordx4 v3, s[44:47], s74 offen lds
    s_add_u32 s74, s74, 16384
    s_add_u32 m0, s50, 2048
    s_nop 0
    buffer_load_dwordx4 v2, s[44:47], s74 offen lds
    s_add_u32 m0, s50, 3072
    s_nop 0
    buffer_load_dwordx4 v3, s[44:47], s74 offen lds
    s_mov_b32 s12, 0x15555556
    v_mul_hi_u32 v9, v0, s12
    v_mul_u32_u24 v10, 2560, v9
    v_lshl_add_u32 v4, v0, 4, v10
    v_add_u32 v8, 64, v0
    v_mul_hi_u32 v9, v8, s12
    v_mul_u32_u24 v10, 2560, v9
    v_lshl_add_u32 v5, v8, 4, v10
    v_add_u32 v8, 128, v0
    v_mul_hi_u32 v9, v8, s12
    v_mul_u32_u24 v10, 2560, v9
    v_lshl_add_u32 v6, v8, 4, v10
    s_lshr_b32 s12, s11, 1
    s_mul_i32 s49, s12, 88064
    s_mul_i32 s13, s7, 192
    s_add_u32 s49, s49, s13
    s_mul_i32 s51, s12, 6144
    s_and_b32 s13, s11, 1
    s_mul_i32 s13, s13, 12320
    s_add_u32 s51, s51, s13
    s_add_u32 s51, s51, 16384
    s_cmp_eq_u32 s7, 15
    s_cselect_b32 s54, 0, 1409024
    s_mov_b32 s55, 0x00020000
    s_bitcmp1_b32 s3, 0
    s_cselect_b32 s52, s32, s30
    s_cselect_b32 s53, s33, s31
    s_add_u32 s12, s10, 0
    s_and_b32 s12, s12, 7
    s_mul_i32 s75, s12, 176128
    s_add_u32 s75, s75, s49
    s_add_u32 m0, s51, 0
    s_nop 0
    buffer_load_dwordx4 v4, s[52:55], s75 offen lds
    s_add_u32 m0, s51, 1024
    s_nop 0
    buffer_load_dwordx4 v5, s[52:55], s75 offen lds
    s_add_u32 m0, s51, 2048
    s_nop 0
    buffer_load_dwordx4 v6, s[52:55], s75 offen lds
    s_add_u32 s75, s75, 44032
    s_add_u32 m0, s51, 3072
    s_nop 0
    buffer_load_dwordx4 v4, s[52:55], s75 offen lds
    s_add_u32 m0, s51, 4096
    s_nop 0
    buffer_load_dwordx4 v5, s[52:55], s75 offen lds
    s_add_u32 m0, s51, 5120
    s_nop 0
    buffer_load_dwordx4 v6, s[52:55], s75 offen lds
    s_lshr_b32 s12, s5, 2
    s_and_b32 s13, s5, 3
    s_lshr_b32 s8, s4, 1
    s_lshl3_add_u32 s8, s8, s12
    s_and_b32 s9, s4, 1
    s_lshl1_add_u32 s9, s13, s9
    s_lshr_b32 s0, s11, 1
    s_and_b32 s1, s11, 1
    v_lshlrev_b32 v7, 4, v0
    s_mov_b32 s56, s40
    s_mov_b32 s57, s41
    s_mov_b32 s58, 12500992
    s_mov_b32 s59, 0x00020000
    s_branch L_backA0
    s_nop 1
L_idleA0:
    s_mov_b32 s12, 0x15555556
    v_mul_hi_u32 v9, v0, s12
    v_mul_u32_u24 v10, 2560, v9
    v_lshl_add_u32 v4, v0, 4, v10
    v_add_u32 v8, 64, v0
    v_mul_hi_u32 v9, v8, s12
    v_mul_u32_u24 v10, 2560, v9
    v_lshl_add_u32 v5, v8, 4, v10
    v_add_u32 v8, 128, v0
    v_mul_hi_u32 v9, v8, s12
    v_mul_u32_u24 v10, 2560, v9
    v_lshl_add_u32 v6, v8, 4, v10
    s_lshr_b32 s12, s11, 1
    s_mul_i32 s49, s12, 88064
    s_mul_i32 s13, s7, 192
    s_add_u32 s49, s49, s13
    s_mul_i32 s51, s12, 6144
    s_and_b32 s13, s11, 1
    s_mul_i32 s13, s13, 12320
    s_add_u32 s51, s51, s13
    s_add_u32 s51, s51, 16384
    s_cmp_eq_u32 s7, 15
    s_cselect_b32 s54, 0, 1409024
    s_mov_b32 s55, 0x00020000
    s_waitcnt lgkmcnt(0)
    s_mov_b32 s44, s16
    s_mov_b32 s45, s17
    s_mov_b32 s52, s30
    s_mov_b32 s53, s31
    s_lshr_b32 s12, s5, 2
    s_and_b32 s13, s5, 3
    s_lshr_b32 s8, s4, 1
    s_lshl3_add_u32 s8, s8, s12
    s_and_b32 s9, s4, 1
    s_lshl1_add_u32 s9, s13, s9
    s_lshr_b32 s0, s11, 1
    s_and_b32 s1, s11, 1
    v_lshlrev_b32 v7, 4, v0
    s_mov_b32 s56, s40
    s_mov_b32 s57, s41
    s_mov_b32 s58, 12500992
    s_mov_b32 s59, 0x00020000
    s_cmp_lg_u32 s3, 0
    s_cbranch_scc1 L_backA0
    s_cmp_lg_u32 s2, 27
    s_cbranch_scc1 L_tag_1
    s_memrealtime s[76:77]
    v_mov_b32 v8, 0
    v_mov_b32 v9, 0
    v_mov_b32 v10, 0
    v_mov_b32 v11, 0
    v_lshlrev_b32 v12, 7, v0
    s_mov_b32 s12, 11960320
    s_mov_b32 s13, 11968512
    buffer_store_dwordx4 v[8:11], v12, s[56:59], s12 offen sc1
    buffer_store_dwordx4 v[8:11], v12, s[56:59], s13 offen sc1
    s_waitcnt lgkmcnt(0)
    s_or_b32 s76, s76, 1
    s_or_b32 s77, s77, 1
    v_mov_b32 v12, s76
    v_mov_b32 v13, s77
    s_waitcnt vmcnt(0)
    s_mov_b64 exec, 1
    global_store_dwordx2 v10, v[12:13], s[38:39] sc1
    s_mov_b64 exec, -1
    s_nop 1
L_tag_1:
    s_nop 1
L_backA0:
    v_and_b32 v20, 31, v0
    v_lshrrev_b32 v21, 5, v0
    v_bfe_u32 v22, v0, 1, 3
    v_xor_b32 v22, v21, v22
    s_lshl_b32 s42, s0, 1
    v_xor_b32 v22, s42, v22
    s_lshl_b32 s42, s0, 13
    v_lshl_add_u32 v20, v20, 7, s42
    v_xor_b32 v23, 0, v22
    v_lshl_add_u32 v8, v23, 4, v20
    v_add_u32 v12, 82048, v8
    v_xor_b32 v23, 2, v22
    v_lshl_add_u32 v9, v23, 4, v20
    v_add_u32 v13, 82048, v9
    v_xor_b32 v23, 4, v22
    v_lshl_add_u32 v10, v23, 4, v20
    v_add_u32 v14, 82048, v10
    v_xor_b32 v23, 6, v22
    v_lshl_add_u32 v11, v23, 4, v20
    v_add_u32 v15, 82048, v11
    v_bfe_u32 v20, v0, 4, 1
    v_mul_u32_u24 v20, 12320, v20
    v_bfe_u32 v22, v0, 2, 2
    v_lshl_add_u32 v22, v21, 3, v22
    v_mul_u32_u24 v22, 192, v22
    v_and_b32 v23, 3, v0
    v_lshl_add_u32 v20, v23, 3, v20
    s_mul_i32 s42, s1, 96
    s_add_u32 s42, s42, 16384
    v_add3_u32 v20, v20, v22, s42
    s_mul_i32 s42, s0, 3072
    v_add_u32 v16, s42, v20
    v_subrev_u32 v17, s42, v20
    v_add_u32 v18, 82048, v16
    v_add_u32 v19, 82048, v17
    v_lshrrev_b32 v20, 2, v0
    v_lshrrev_b32 v21, 4, v0
    v_xor_b32 v20, v20, v21
    v_and_b32 v20, 1, v20
    v_cmp_eq_u32 vcc, 0, v20
    v_mov_b32 v21, 0x3f803f80
    s_nop 0
    v_cndmask_b32 v36, 0, v21, vcc
    v_mov_b32 v37, v36
    v_mov_b32 v38, v36
    v_mov_b32 v39, v36
    s_lshl_b32 s12, s11, 2
    s_add_u32 s12, s12, 163600
    v_mov_b32 v253, s12
    v_mov_b32 v254, 163600
    s_lshl_b32 s12, s11, 10
    s_add_u32 s12, s12, 158400
    v_add_u32 v20, s12, v7
    s_xor_b32 s12, s11, 2
    s_lshl_b32 s12, s12, 10
    s_add_u32 s12, s12, 158400
    v_and_b32 v1, 31, v0
    v_lshl_add_u32 v21, v1, 4, s12
    s_lshl_b32 s12, s0, 9
    s_add_u32 s12, s12, 162496
    v_lshl_add_u32 v1, v1, 3, s12
    v_mov_b32 v63, 1
    s_mov_b32 s70, -1
    s_mov_b32 s71, 0
    v_mov_b32 v226, 0
    v_mov_b32 v227, 0
    v_mov_b32 v230, 0
    v_mov_b32 v231, 0
    v_mov_b32 v234, 0
    v_mov_b32 v235, 0
    v_mov_b32 v238, 0
    v_mov_b32 v239, 0
    v_mov_b32 v242, 0
    v_mov_b32 v243, 0
    s_cmp_eq_u32 s7, 15
    s_cbranch_scc1 L_idleA
    s_add_u32 s12, s10, 1
    s_and_b32 s12, s12, 7
    s_lshl_b32 s74, s12, 7
    s_add_u32 s74, s74, s48
    s_mul_i32 s75, s12, 176128
    s_add_u32 s75, s75, s49
    s_add_u32 m0, s50, 41024
    s_nop 0
    buffer_load_dwordx4 v2, s[44:47], s74 offen lds
    s_add_u32 m0, s50, 42048
    s_nop 0
    buffer_load_dwordx4 v3, s[44:47], s74 offen lds
    s_add_u32 s74, s74, 16384
    s_add_u32 m0, s50, 43072
    s_nop 0
    buffer_load_dwordx4 v2, s[44:47], s74 offen lds
    s_add_u32 m0, s50, 44096
    s_nop 0
    buffer_load_dwordx4 v3, s[44:47], s74 offen lds
    s_add_u32 m0, s51, 41024
    s_nop 0
    buffer_load_dwordx4 v4, s[52:55], s75 offen lds
    s_add_u32 m0, s51, 42048
    s_nop 0
    buffer_load_dwordx4 v5, s[52:55], s75 offen lds
    s_add_u32 m0, s51, 43072
    s_nop 0
    buffer_load_dwordx4 v6, s[52:55], s75 offen lds
    s_add_u32 s75, s75, 44032
    s_add_u32 m0, s51, 44096
    s_nop 0
    buffer_load_dwordx4 v4, s[52:55], s75 offen lds
    s_add_u32 m0, s51, 45120
    s_nop 0
    buffer_load_dwordx4 v5, s[52:55], s75 offen lds
    s_add_u32 m0, s51, 46144
    s_nop 0
    buffer_load_dwordx4 v6, s[52:55], s75 offen lds
    s_lshl_b32 s12, s6, 2
    s_lshl_b32 s13, s0, 1
    s_add_u32 s12, s12, s13
    s_mul_i32 s12, s12, 88064
    s_add_u32 s60, s40, s12
    s_addc_u32 s61, s41, 0
    s_mov_b32 s62, 88064
    s_mov_b32 s63, 0x00020000
    s_add_u32 s12, s12, 88064
    s_add_u32 s64, s40, s12
    s_addc_u32 s65, s41, 0
    s_mov_b32 s66, 88064
    s_mov_b32 s67, 0x00020000
    s_lshl_b32 s13, s7, 1
    s_add_u32 s13, s13, s1
    s_mul_i32 s74, s13, 3072
    s_lshl_b32 s12, s6, 1
    s_add_u32 s12, s12, s0
    s_lshl_b32 s12, s12, 8
    s_cmp_ge_u32 s13, 15
    s_cselect_b32 s42, 128, 0
    s_add_u32 s12, s12, s42
    s_add_u32 s75, s12, 11960320
    s_cmp_ge_u32 s13, 30
    s_cselect_b32 s75, 12500992, s75
    s_mov_b32 s68, 0xbdd2d3e8
    s_mov_b32 s69, 0xc0135761
    v_mov_b32 v246, 0
    v_mov_b32 v247, 1
    v_lshrrev_b32 v32, 5, v0
    v_bfe_u32 v33, v0, 2, 2
    v_lshl_add_u32 v32, v32, 2, v33
    v_lshlrev_b32 v32, 7, v32
    v_bfe_u32 v34, v0, 4, 1
    v_lshl_add_u32 v32, v34, 5, v32
    v_and_b32 v34, 3, v0
    v_lshl_add_u32 v32, v34, 3, v32
    v_bfe_u32 v34, v0, 3, 1
    v_lshl_add_u32 v33, v34, 6, v32
    v_xor_b32 v34, 64, v33
    s_mul_i32 s12, s0, 20480
    v_add_u32 v250, s12, v33
    v_add_u32 v251, s12, v34
    v_add_u32 v248, 82048, v250
    v_add_u32 v249, 82048, v251
    s_lshl_b32 s12, s0, 3
    s_add_u32 s13, s12, 163584
    v_mov_b32 v252, s13
    s_add_u32 s12, s12, 163600
    v_mov_b32 v254, s12
    v_lshrrev_b32 v32, 3, v0
    v_and_b32 v33, 7, v0
    v_bfe_u32 v34, v0, 4, 1
    v_lshlrev_b32 v34, 2, v34
    v_xor_b32 v33, v33, v34
    v_lshlrev_b32 v33, 4, v33
    v_lshl_add_u32 v245, v32, 10, v33
    s_mul_i32 s72, s0, 737280
    s_lshl_b32 s12, s1, 13
    s_add_u32 s72, s72, s12
    s_lshl_b32 s12, s9, 7
    s_add_u32 s72, s72, s12
    s_mul_i32 s73, s0, 20480
    s_lshl_b32 s12, s1, 10
    s_add_u32 s73, s73, s12
    s_lshl_b32 s12, s8, 8
    s_lshl_b32 s13, s0, 7
    s_add_u32 s12, s12, s13
    s_add_u32 s78, s12, 11960320
    s_mul_i32 s79, s0, 46080
    s_lshl_b32 s12, s8, 1
    s_add_u32 s12, s12, s1
    s_mul_i32 s12, s12, 88064
    s_add_u32 s80, s40, s12
    s_addc_u32 s81, s41, 0
    s_mov_b32 s82, 88064
    s_mov_b32 s83, 0x00020000
    s_mov_b32 s84, s34
    s_mov_b32 s85, s35
    s_mov_b32 s86, 1409024
    s_mov_b32 s87, 0x00020000
    v_mov_b32 v2, 3
    s_waitcnt vmcnt(10)
    s_barrier
    ds_read_b128 v[64:67], v8 offset:0
    ds_read_b64_tr_b16 v[72:73], v16 offset:0
    ds_read_b64_tr_b16 v[74:75], v16 offset:768
    ds_read_b128 v[68:71], v8 offset:4096
    ds_read_b64_tr_b16 v[76:77], v16 offset:32
    ds_read_b64_tr_b16 v[78:79], v16 offset:800
    ds_read_b64_tr_b16 v[80:81], v16 offset:64
    ds_read_b64_tr_b16 v[82:83], v16 offset:832
    s_waitcnt lgkmcnt(0)
    v_mfma_f32_32x32x16_bf16 v[128:143], v[72:75], v[64:67], 0
    ds_read_b128 v[84:87], v9 offset:0
    ds_read_b64_tr_b16 v[92:93], v17 offset:3072
    v_mfma_f32_32x32x16_bf16 v[176:191], v[72:75], v[68:71], 0
    ds_read_b64_tr_b16 v[94:95], v17 offset:3840
    ds_read_b128 v[88:91], v9 offset:4096
    v_mfma_f32_16x16x32_bf16 v[24:27], v[36:39], v[72:75], 0
    v_mfma_f32_32x32x16_bf16 v[144:159], v[76:79], v[64:67], 0
    ds_read_b64_tr_b16 v[96:97], v17 offset:3104
    ds_read_b64_tr_b16 v[98:99], v17 offset:3872
    v_mfma_f32_32x32x16_bf16 v[192:207], v[76:79], v[68:71], 0
    ds_read_b64_tr_b16 v[100:101], v17 offset:3136
    ds_read_b64_tr_b16 v[102:103], v17 offset:3904
    v_mfma_f32_32x32x16_bf16 v[160:175], v[80:83], v[64:67], 0
    v_mfma_f32_16x16x32_bf16 v[28:31], v[36:39], v[76:79], 0
    v_mfma_f32_32x32x16_bf16 v[208:223], v[80:83], v[68:71], 0
    s_waitcnt lgkmcnt(0)
    v_mfma_f32_32x32x16_bf16 v[128:143], v[92:95], v[84:87], v[128:143]
    ds_read_b128 v[104:107], v10 offset:0
    ds_read_b64_tr_b16 v[112:113], v16 offset:6144
    v_mfma_f32_32x32x16_bf16 v[176:191], v[92:95], v[88:91], v[176:191]
    ds_read_b64_tr_b16 v[114:115], v16 offset:6912
    ds_read_b128 v[108:111], v10 offset:4096
    v_mfma_f32_32x32x16_bf16 v[144:159], v[96:99], v[84:87], v[144:159]
    ds_read_b64_tr_b16 v[116:117], v16 offset:6176
    ds_read_b64_tr_b16 v[118:119], v16 offset:6944
    v_mfma_f32_16x16x32_bf16 v[32:35], v[36:39], v[80:83], 0
    v_mfma_f32_32x32x16_bf16 v[192:207], v[96:99], v[88:91], v[192:207]
    ds_read_b64_tr_b16 v[120:121], v16 offset:6208
    ds_read_b64_tr_b16 v[122:123], v16 offset:6976
    v_mfma_f32_32x32x16_bf16 v[160:175], v[100:103], v[84:87], v[160:175]
    v_mfma_f32_32x32x16_bf16 v[208:223], v[100:103], v[88:91], v[208:223]
    s_waitcnt lgkmcnt(0)
    v_mfma_f32_32x32x16_bf16 v[128:143], v[112:115], v[104:107], v[128:143]
    ds_read_b128 v[64:67], v11 offset:0
    ds_read_b64_tr_b16 v[72:73], v17 offset:9216
    v_mfma_f32_32x32x16_bf16 v[176:191], v[112:115], v[108:111], v[176:191]
    ds_read_b64_tr_b16 v[74:75], v17 offset:9984
    ds_read_b128 v[68:71], v11 offset:4096
    v_mfma_f32_16x16x32_bf16 v[24:27], v[36:39], v[112:115], v[24:27]
    v_mfma_f32_32x32x16_bf16 v[144:159], v[116:119], v[104:107], v[144:159]
    ds_read_b64_tr_b16 v[76:77], v17 offset:9248
    ds_read_b64_tr_b16 v[78:79], v17 offset:10016
    v_mfma_f32_32x32x16_bf16 v[192:207], v[116:119], v[108:111], v[192:207]
    ds_read_b64_tr_b16 v[80:81], v17 offset:9280
    ds_read_b64_tr_b16 v[82:83], v17 offset:10048
    v_mfma_f32_32x32x16_bf16 v[160:175], v[120:123], v[104:107], v[160:175]
    v_mfma_f32_16x16x32_bf16 v[28:31], v[36:39], v[116:119], v[28:31]
    v_mfma_f32_32x32x16_bf16 v[208:223], v[120:123], v[108:111], v[208:223]
    s_waitcnt lgkmcnt(0)
    s_waitcnt vmcnt(0)
    s_barrier
    v_mfma_f32_32x32x16_bf16 v[128:143], v[72:75], v[64:67], v[128:143]
    ds_read_b128 v[84:87], v8 offset:41024
    ds_read_b64_tr_b16 v[92:93], v16 offset:41024
    v_mfma_f32_32x32x16_bf16 v[176:191], v[72:75], v[68:71], v[176:191]
    ds_read_b64_tr_b16 v[94:95], v16 offset:41792
    ds_read_b128 v[88:91], v8 offset:45120
    v_mfma_f32_32x32x16_bf16 v[144:159], v[76:79], v[64:67], v[144:159]
    ds_read_b64_tr_b16 v[96:97], v16 offset:41056
    ds_read_b64_tr_b16 v[98:99], v16 offset:41824
    v_mfma_f32_16x16x32_bf16 v[32:35], v[36:39], v[120:123], v[32:35]
    v_mfma_f32_32x32x16_bf16 v[192:207], v[76:79], v[68:71], v[192:207]
    ds_read_b64_tr_b16 v[100:101], v16 offset:41088
    ds_read_b64_tr_b16 v[102:103], v16 offset:41856
    v_mfma_f32_32x32x16_bf16 v[160:175], v[80:83], v[64:67], v[160:175]
    v_mfma_f32_32x32x16_bf16 v[208:223], v[80:83], v[68:71], v[208:223]
    s_waitcnt lgkmcnt(0)
    v_mfma_f32_32x32x16_bf16 v[128:143], v[92:95], v[84:87], v[128:143]
    ds_read_b128 v[104:107], v9 offset:41024
    ds_read_b64_tr_b16 v[112:113], v17 offset:44096
    v_mfma_f32_32x32x16_bf16 v[176:191], v[92:95], v[88:91], v[176:191]
    ds_read_b64_tr_b16 v[114:115], v17 offset:44864
    ds_read_b128 v[108:111], v9 offset:45120
    v_mfma_f32_16x16x32_bf16 v[24:27], v[36:39], v[92:95], v[24:27]
    v_mfma_f32_32x32x16_bf16 v[144:159], v[96:99], v[84:87], v[144:159]
    ds_read_b64_tr_b16 v[116:117], v17 offset:44128
    ds_read_b64_tr_b16 v[118:119], v17 offset:44896
    v_mfma_f32_32x32x16_bf16 v[192:207], v[96:99], v[88:91], v[192:207]
    ds_read_b64_tr_b16 v[120:121], v17 offset:44160
    ds_read_b64_tr_b16 v[122:123], v17 offset:44928
    v_mfma_f32_32x32x16_bf16 v[160:175], v[100:103], v[84:87], v[160:175]
    v_mfma_f32_16x16x32_bf16 v[28:31], v[36:39], v[96:99], v[28:31]
    v_mfma_f32_32x32x16_bf16 v[208:223], v[100:103], v[88:91], v[208:223]
    s_waitcnt lgkmcnt(0)
    v_mfma_f32_32x32x16_bf16 v[128:143], v[112:115], v[104:107], v[128:143]
    ds_read_b128 v[64:67], v10 offset:41024
    ds_read_b64_tr_b16 v[72:73], v16 offset:47168
    v_mfma_f32_32x32x16_bf16 v[176:191], v[112:115], v[108:111], v[176:191]
    ds_read_b64_tr_b16 v[74:75], v16 offset:47936
    ds_read_b128 v[68:71], v10 offset:45120
    v_mfma_f32_32x32x16_bf16 v[144:159], v[116:119], v[104:107], v[144:159]
    ds_read_b64_tr_b16 v[76:77], v16 offset:47200
    ds_read_b64_tr_b16 v[78:79], v16 offset:47968
    v_mfma_f32_16x16x32_bf16 v[32:35], v[36:39], v[100:103], v[32:35]
    v_mfma_f32_32x32x16_bf16 v[192:207], v[116:119], v[108:111], v[192:207]
    ds_read_b64_tr_b16 v[80:81], v16 offset:47232
    ds_read_b64_tr_b16 v[82:83], v16 offset:48000
    v_mfma_f32_32x32x16_bf16 v[160:175], v[120:123], v[104:107], v[160:175]
    v_mfma_f32_32x32x16_bf16 v[208:223], v[120:123], v[108:111], v[208:223]
    s_waitcnt lgkmcnt(0)
    v_mfma_f32_32x32x16_bf16 v[128:143], v[72:75], v[64:67], v[128:143]
    ds_read_b128 v[84:87], v11 offset:41024
    ds_read_b64_tr_b16 v[92:93], v17 offset:50240
    v_mfma_f32_32x32x16_bf16 v[176:191], v[72:75], v[68:71], v[176:191]
    ds_read_b64_tr_b16 v[94:95], v17 offset:51008
    ds_read_b128 v[88:91], v11 offset:45120
    v_mfma_f32_16x16x32_bf16 v[24:27], v[36:39], v[72:75], v[24:27]
    v_mfma_f32_32x32x16_bf16 v[144:159], v[76:79], v[64:67], v[144:159]
    ds_read_b64_tr_b16 v[96:97], v17 offset:50272
    ds_read_b64_tr_b16 v[98:99], v17 offset:51040
    v_mfma_f32_32x32x16_bf16 v[192:207], v[76:79], v[68:71], v[192:207]
    ds_read_b64_tr_b16 v[100:101], v17 offset:50304
    ds_read_b64_tr_b16 v[102:103], v17 offset:51072
    v_mfma_f32_32x32x16_bf16 v[160:175], v[80:83], v[64:67], v[160:175]
    v_mfma_f32_16x16x32_bf16 v[28:31], v[36:39], v[76:79], v[28:31]
    v_mfma_f32_32x32x16_bf16 v[208:223], v[80:83], v[68:71], v[208:223]
    s_waitcnt lgkmcnt(0)
    s_barrier
    v_mfma_f32_32x32x16_bf16 v[128:143], v[92:95], v[84:87], v[128:143]
    ds_read_b128 v[104:107], v12 offset:0
    ds_read_b64_tr_b16 v[112:113], v18 offset:0
    v_mfma_f32_32x32x16_bf16 v[176:191], v[92:95], v[88:91], v[176:191]
    ds_read_b64_tr_b16 v[114:115], v18 offset:768
    ds_read_b128 v[108:111], v12 offset:4096
    v_mfma_f32_32x32x16_bf16 v[144:159], v[96:99], v[84:87], v[144:159]
    ds_read_b64_tr_b16 v[116:117], v18 offset:32
    ds_read_b64_tr_b16 v[118:119], v18 offset:800
    v_mfma_f32_16x16x32_bf16 v[32:35], v[36:39], v[80:83], v[32:35]
    v_mfma_f32_32x32x16_bf16 v[192:207], v[96:99], v[88:91], v[192:207]
    ds_read_b64_tr_b16 v[120:121], v18 offset:64
    ds_read_b64_tr_b16 v[122:123], v18 offset:832
    v_mfma_f32_32x32x16_bf16 v[160:175], v[100:103], v[84:87], v[160:175]
    v_mfma_f32_32x32x16_bf16 v[208:223], v[100:103], v[88:91], v[208:223]
    s_waitcnt lgkmcnt(0)
    v_mfma_f32_32x32x16_bf16 v[128:143], v[112:115], v[104:107], v[128:143]
    ds_read_b128 v[64:67], v13 offset:0
    ds_read_b64_tr_b16 v[72:73], v19 offset:3072
    v_mfma_f32_32x32x16_bf16 v[176:191], v[112:115], v[108:111], v[176:191]
    ds_read_b64_tr_b16 v[74:75], v19 offset:3840
    ds_read_b128 v[68:71], v13 offset:4096
    v_mfma_f32_16x16x32_bf16 v[24:27], v[36:39], v[112:115], v[24:27]
    v_mfma_f32_32x32x16_bf16 v[144:159], v[116:119], v[104:107], v[144:159]
    ds_read_b64_tr_b16 v[76:77], v19 offset:3104
    ds_read_b64_tr_b16 v[78:79], v19 offset:3872
    v_mfma_f32_32x32x16_bf16 v[192:207], v[116:119], v[108:111], v[192:207]
    ds_read_b64_tr_b16 v[80:81], v19 offset:3136
    ds_read_b64_tr_b16 v[82:83], v19 offset:3904
    v_mfma_f32_32x32x16_bf16 v[160:175], v[120:123], v[104:107], v[160:175]
    v_mfma_f32_16x16x32_bf16 v[28:31], v[36:39], v[116:119], v[28:31]
    v_mfma_f32_32x32x16_bf16 v[208:223], v[120:123], v[108:111], v[208:223]
    s_waitcnt lgkmcnt(0)
    v_mfma_f32_32x32x16_bf16 v[128:143], v[72:75], v[64:67], v[128:143]
    ds_read_b128 v[84:87], v14 offset:0
    ds_read_b64_tr_b16 v[92:93], v18 offset:6144
    v_mfma_f32_32x32x16_bf16 v[176:191], v[72:75], v[68:71], v[176:191]
    ds_read_b64_tr_b16 v[94:95], v18 offset:6912
    ds_read_b128 v[88:91], v14 offset:4096
    v_mfma_f32_32x32x16_bf16 v[144:159], v[76:79], v[64:67], v[144:159]
    ds_read_b64_tr_b16 v[96:97], v18 offset:6176
    ds_read_b64_tr_b16 v[98:99], v18 offset:6944
    v_mfma_f32_16x16x32_bf16 v[32:35], v[36:39], v[120:123], v[32:35]
    v_mfma_f32_32x32x16_bf16 v[192:207], v[76:79], v[68:71], v[192:207]
    ds_read_b64_tr_b16 v[100:101], v18 offset:6208
    ds_read_b64_tr_b16 v[102:103], v18 offset:6976
    v_mfma_f32_32x32x16_bf16 v[160:175], v[80:83], v[64:67], v[160:175]
    v_mfma_f32_32x32x16_bf16 v[208:223], v[80:83], v[68:71], v[208:223]
    s_waitcnt lgkmcnt(0)
    v_mfma_f32_32x32x16_bf16 v[128:143], v[92:95], v[84:87], v[128:143]
    ds_read_b128 v[104:107], v15 offset:0
    ds_read_b64_tr_b16 v[112:113], v19 offset:9216
    v_mfma_f32_32x32x16_bf16 v[176:191], v[92:95], v[88:91], v[176:191]
    ds_read_b64_tr_b16 v[114:115], v19 offset:9984
    ds_read_b128 v[108:111], v15 offset:4096
    v_mfma_f32_16x16x32_bf16 v[24:27], v[36:39], v[92:95], v[24:27]
    v_mfma_f32_32x32x16_bf16 v[144:159], v[96:99], v[84:87], v[144:159]
    ds_read_b64_tr_b16 v[116:117], v19 offset:9248
    ds_read_b64_tr_b16 v[118:119], v19 offset:10016
    v_mfma_f32_32x32x16_bf16 v[192:207], v[96:99], v[88:91], v[192:207]
    ds_read_b64_tr_b16 v[120:121], v19 offset:9280
    ds_read_b64_tr_b16 v[122:123], v19 offset:10048
    v_mfma_f32_32x32x16_bf16 v[160:175], v[100:103], v[84:87], v[160:175]
    v_mfma_f32_16x16x32_bf16 v[28:31], v[36:39], v[96:99], v[28:31]
    v_mfma_f32_32x32x16_bf16 v[208:223], v[100:103], v[88:91], v[208:223]
    s_waitcnt lgkmcnt(0)
    s_barrier
    v_mfma_f32_32x32x16_bf16 v[128:143], v[112:115], v[104:107], v[128:143]
    ds_read_b128 v[64:67], v8 offset:0
    ds_read_b64_tr_b16 v[72:73], v16 offset:0
    v_mfma_f32_32x32x16_bf16 v[176:191], v[112:115], v[108:111], v[176:191]
    ds_read_b64_tr_b16 v[74:75], v16 offset:768
    ds_read_b128 v[68:71], v8 offset:4096
    v_mfma_f32_32x32x16_bf16 v[144:159], v[116:119], v[104:107], v[144:159]
    ds_read_b64_tr_b16 v[76:77], v16 offset:32
    ds_read_b64_tr_b16 v[78:79], v16 offset:800
    v_mfma_f32_16x16x32_bf16 v[32:35], v[36:39], v[100:103], v[32:35]
    v_mfma_f32_32x32x16_bf16 v[192:207], v[116:119], v[108:111], v[192:207]
    ds_read_b64_tr_b16 v[80:81], v16 offset:64
    ds_read_b64_tr_b16 v[82:83], v16 offset:832
    v_mfma_f32_32x32x16_bf16 v[160:175], v[120:123], v[104:107], v[160:175]
    v_mfma_f32_32x32x16_bf16 v[208:223], v[120:123], v[108:111], v[208:223]
    s_waitcnt lgkmcnt(0)
    v_mfma_f32_32x32x16_bf16 v[128:143], v[72:75], v[64:67], v[128:143]
    ds_read_b128 v[84:87], v9 offset:0
    ds_read_b64_tr_b16 v[92:93], v17 offset:3072
    v_mfma_f32_32x32x16_bf16 v[176:191], v[72:75], v[68:71], v[176:191]
    ds_read_b64_tr_b16 v[94:95], v17 offset:3840
    ds_read_b128 v[88:91], v9 offset:4096
    v_mfma_f32_16x16x32_bf16 v[24:27], v[36:39], v[72:75], v[24:27]
    v_mfma_f32_32x32x16_bf16 v[144:159], v[76:79], v[64:67], v[144:159]
    ds_read_b64_tr_b16 v[96:97], v17 offset:3104
    ds_read_b64_tr_b16 v[98:99], v17 offset:3872
    v_mfma_f32_32x32x16_bf16 v[192:207], v[76:79], v[68:71], v[192:207]
    ds_read_b64_tr_b16 v[100:101], v17 offset:3136
    ds_read_b64_tr_b16 v[102:103], v17 offset:3904
    v_mfma_f32_32x32x16_bf16 v[160:175], v[80:83], v[64:67], v[160:175]
    v_mfma_f32_16x16x32_bf16 v[28:31], v[36:39], v[76:79], v[28:31]
    v_mfma_f32_32x32x16_bf16 v[208:223], v[80:83], v[68:71], v[208:223]
    s_waitcnt lgkmcnt(0)
    v_mfma_f32_32x32x16_bf16 v[128:143], v[92:95], v[84:87], v[128:143]
    ds_read_b128 v[104:107], v10 offset:0
    ds_read_b64_tr_b16 v[112:113], v16 offset:6144
    v_mfma_f32_32x32x16_bf16 v[176:191], v[92:95], v[88:91], v[176:191]
    ds_read_b64_tr_b16 v[114:115], v16 offset:6912
    ds_read_b128 v[108:111], v10 offset:4096
    v_mfma_f32_32x32x16_bf16 v[144:159], v[96:99], v[84:87], v[144:159]
    ds_read_b64_tr_b16 v[116:117], v16 offset:6176
    ds_read_b64_tr_b16 v[118:119], v16 offset:6944
    v_mfma_f32_16x16x32_bf16 v[32:35], v[36:39], v[80:83], v[32:35]
    v_mfma_f32_32x32x16_bf16 v[192:207], v[96:99], v[88:91], v[192:207]
    ds_read_b64_tr_b16 v[120:121], v16 offset:6208
    ds_read_b64_tr_b16 v[122:123], v16 offset:6976
    v_mfma_f32_32x32x16_bf16 v[160:175], v[100:103], v[84:87], v[160:175]
    v_mfma_f32_32x32x16_bf16 v[208:223], v[100:103], v[88:91], v[208:223]
    s_waitcnt lgkmcnt(0)
    v_mfma_f32_32x32x16_bf16 v[128:143], v[112:115], v[104:107], v[128:143]
    ds_read_b128 v[64:67], v11 offset:0
    ds_read_b64_tr_b16 v[72:73], v17 offset:9216
    v_mfma_f32_32x32x16_bf16 v[176:191], v[112:115], v[108:111], v[176:191]
    ds_read_b64_tr_b16 v[74:75], v17 offset:9984
    ds_read_b128 v[68:71], v11 offset:4096
    v_mfma_f32_16x16x32_bf16 v[24:27], v[36:39], v[112:115], v[24:27]
    v_mfma_f32_32x32x16_bf16 v[144:159], v[116:119], v[104:107], v[144:159]
    ds_read_b64_tr_b16 v[76:77], v17 offset:9248
    ds_read_b64_tr_b16 v[78:79], v17 offset:10016
    v_mfma_f32_32x32x16_bf16 v[192:207], v[116:119], v[108:111], v[192:207]
    ds_read_b64_tr_b16 v[80:81], v17 offset:9280
    ds_read_b64_tr_b16 v[82:83], v17 offset:10048
    v_mfma_f32_32x32x16_bf16 v[160:175], v[120:123], v[104:107], v[160:175]
    v_mfma_f32_16x16x32_bf16 v[28:31], v[36:39], v[116:119], v[28:31]
    v_mfma_f32_32x32x16_bf16 v[208:223], v[120:123], v[108:111], v[208:223]
    s_waitcnt lgkmcnt(0)
    s_barrier
    v_mfma_f32_32x32x16_bf16 v[128:143], v[72:75], v[64:67], v[128:143]
    ds_read_b128 v[84:87], v8 offset:41024
    ds_read_b64_tr_b16 v[92:93], v16 offset:41024
    v_mfma_f32_32x32x16_bf16 v[176:191], v[72:75], v[68:71], v[176:191]
    ds_read_b64_tr_b16 v[94:95], v16 offset:41792
    ds_read_b128 v[88:91], v8 offset:45120
    v_mfma_f32_32x32x16_bf16 v[144:159], v[76:79], v[64:67], v[144:159]
    ds_read_b64_tr_b16 v[96:97], v16 offset:41056
    ds_read_b64_tr_b16 v[98:99], v16 offset:41824
    v_mfma_f32_16x16x32_bf16 v[32:35], v[36:39], v[120:123], v[32:35]
    v_mfma_f32_32x32x16_bf16 v[192:207], v[76:79], v[68:71], v[192:207]
    ds_read_b64_tr_b16 v[100:101], v16 offset:41088
    ds_read_b64_tr_b16 v[102:103], v16 offset:41856
    v_mfma_f32_32x32x16_bf16 v[160:175], v[80:83], v[64:67], v[160:175]
    v_mfma_f32_32x32x16_bf16 v[208:223], v[80:83], v[68:71], v[208:223]
    s_waitcnt lgkmcnt(0)
    v_mfma_f32_32x32x16_bf16 v[128:143], v[92:95], v[84:87], v[128:143]
    ds_read_b128 v[104:107], v9 offset:41024
    ds_read_b64_tr_b16 v[112:113], v17 offset:44096
    v_mfma_f32_32x32x16_bf16 v[176:191], v[92:95], v[88:91], v[176:191]
    ds_read_b64_tr_b16 v[114:115], v17 offset:44864
    ds_read_b128 v[108:111], v9 offset:45120
    v_mfma_f32_16x16x32_bf16 v[24:27], v[36:39], v[92:95], v[24:27]
    v_mfma_f32_32x32x16_bf16 v[144:159], v[96:99], v[84:87], v[144:159]
    ds_read_b64_tr_b16 v[116:117], v17 offset:44128
    ds_read_b64_tr_b16 v[118:119], v17 offset:44896
    v_mfma_f32_32x32x16_bf16 v[192:207], v[96:99], v[88:91], v[192:207]
    ds_read_b64_tr_b16 v[120:121], v17 offset:44160
    ds_read_b64_tr_b16 v[122:123], v17 offset:44928
    v_mfma_f32_32x32x16_bf16 v[160:175], v[100:103], v[84:87], v[160:175]
    v_mfma_f32_16x16x32_bf16 v[28:31], v[36:39], v[96:99], v[28:31]
    v_mfma_f32_32x32x16_bf16 v[208:223], v[100:103], v[88:91], v[208:223]
    s_waitcnt lgkmcnt(0)
    v_mfma_f32_32x32x16_bf16 v[128:143], v[112:115], v[104:107], v[128:143]
    ds_read_b128 v[64:67], v10 offset:41024
    ds_read_b64_tr_b16 v[72:73], v16 offset:47168
    v_mfma_f32_32x32x16_bf16 v[176:191], v[112:115], v[108:111], v[176:191]
    ds_read_b64_tr_b16 v[74:75], v16 offset:47936
    ds_read_b128 v[68:71], v10 offset:45120
    v_mfma_f32_32x32x16_bf16 v[144:159], v[116:119], v[104:107], v[144:159]
    ds_read_b64_tr_b16 v[76:77], v16 offset:47200
    ds_read_b64_tr_b16 v[78:79], v16 offset:47968
    v_mfma_f32_16x16x32_bf16 v[32:35], v[36:39], v[100:103], v[32:35]
    v_mfma_f32_32x32x16_bf16 v[192:207], v[116:119], v[108:111], v[192:207]
    ds_read_b64_tr_b16 v[80:81], v16 offset:47232
    ds_read_b64_tr_b16 v[82:83], v16 offset:48000
    v_mfma_f32_32x32x16_bf16 v[160:175], v[120:123], v[104:107], v[160:175]
    v_mfma_f32_32x32x16_bf16 v[208:223], v[120:123], v[108:111], v[208:223]
    s_waitcnt lgkmcnt(0)
    v_mfma_f32_32x32x16_bf16 v[128:143], v[72:75], v[64:67], v[128:143]
    ds_read_b128 v[84:87], v11 offset:41024
    ds_read_b64_tr_b16 v[92:93], v17 offset:50240
    v_mfma_f32_32x32x16_bf16 v[176:191], v[72:75], v[68:71], v[176:191]
    ds_read_b64_tr_b16 v[94:95], v17 offset:51008
    ds_read_b128 v[88:91], v11 offset:45120
    v_mfma_f32_16x16x32_bf16 v[24:27], v[36:39], v[72:75], v[24:27]
    v_mfma_f32_32x32x16_bf16 v[144:159], v[76:79], v[64:67], v[144:159]
    ds_read_b64_tr_b16 v[96:97], v17 offset:50272
    ds_read_b64_tr_b16 v[98:99], v17 offset:51040
    v_mfma_f32_32x32x16_bf16 v[192:207], v[76:79], v[68:71], v[192:207]
    ds_read_b64_tr_b16 v[100:101], v17 offset:50304
    ds_read_b64_tr_b16 v[102:103], v17 offset:51072
    v_mfma_f32_32x32x16_bf16 v[160:175], v[80:83], v[64:67], v[160:175]
    v_mfma_f32_16x16x32_bf16 v[28:31], v[36:39], v[76:79], v[28:31]
    v_mfma_f32_32x32x16_bf16 v[208:223], v[80:83], v[68:71], v[208:223]
    s_waitcnt lgkmcnt(0)
    s_barrier
    v_mfma_f32_32x32x16_bf16 v[128:143], v[92:95], v[84:87], v[128:143]
    ds_read_b128 v[104:107], v12 offset:0
    ds_read_b64_tr_b16 v[112:113], v18 offset:0
    v_mfma_f32_32x32x16_bf16 v[176:191], v[92:95], v[88:91], v[176:191]
    ds_read_b64_tr_b16 v[114:115], v18 offset:768
    ds_read_b128 v[108:111], v12 offset:4096
    v_mfma_f32_32x32x16_bf16 v[144:159], v[96:99], v[84:87], v[144:159]
    ds_read_b64_tr_b16 v[116:117], v18 offset:32
    ds_read_b64_tr_b16 v[118:119], v18 offset:800
    v_mfma_f32_16x16x32_bf16 v[32:35], v[36:39], v[80:83], v[32:35]
    v_mfma_f32_32x32x16_bf16 v[192:207], v[96:99], v[88:91], v[192:207]
    ds_read_b64_tr_b16 v[120:121], v18 offset:64
    ds_read_b64_tr_b16 v[122:123], v18 offset:832
    v_mfma_f32_32x32x16_bf16 v[160:175], v[100:103], v[84:87], v[160:175]
    v_mfma_f32_32x32x16_bf16 v[208:223], v[100:103], v[88:91], v[208:223]
    s_waitcnt lgkmcnt(0)
    v_mfma_f32_32x32x16_bf16 v[128:143], v[112:115], v[104:107], v[128:143]
    ds_read_b128 v[64:67], v13 offset:0
    ds_read_b64_tr_b16 v[72:73], v19 offset:3072
    v_mfma_f32_32x32x16_bf16 v[176:191], v[112:115], v[108:111], v[176:191]
    ds_read_b64_tr_b16 v[74:75], v19 offset:3840
    ds_read_b128 v[68:71], v13 offset:4096
    v_mfma_f32_16x16x32_bf16 v[24:27], v[36:39], v[112:115], v[24:27]
    v_mfma_f32_32x32x16_bf16 v[144:159], v[116:119], v[104:107], v[144:159]
    ds_read_b64_tr_b16 v[76:77], v19 offset:3104
    ds_read_b64_tr_b16 v[78:79], v19 offset:3872
    v_mfma_f32_32x32x16_bf16 v[192:207], v[116:119], v[108:111], v[192:207]
    ds_read_b64_tr_b16 v[80:81], v19 offset:3136
    ds_read_b64_tr_b16 v[82:83], v19 offset:3904
    v_mfma_f32_32x32x16_bf16 v[160:175], v[120:123], v[104:107], v[160:175]
    v_mfma_f32_16x16x32_bf16 v[28:31], v[36:39], v[116:119], v[28:31]
    v_mfma_f32_32x32x16_bf16 v[208:223], v[120:123], v[108:111], v[208:223]
    s_waitcnt lgkmcnt(0)
    v_mfma_f32_32x32x16_bf16 v[128:143], v[72:75], v[64:67], v[128:143]
    ds_read_b128 v[84:87], v14 offset:0
    ds_read_b64_tr_b16 v[92:93], v18 offset:6144
    v_mfma_f32_32x32x16_bf16 v[176:191], v[72:75], v[68:71], v[176:191]
    ds_read_b64_tr_b16 v[94:95], v18 offset:6912
    ds_read_b128 v[88:91], v14 offset:4096
    v_mfma_f32_32x32x16_bf16 v[144:159], v[76:79], v[64:67], v[144:159]
    ds_read_b64_tr_b16 v[96:97], v18 offset:6176
    ds_read_b64_tr_b16 v[98:99], v18 offset:6944
    v_mfma_f32_16x16x32_bf16 v[32:35], v[36:39], v[120:123], v[32:35]
    v_mfma_f32_32x32x16_bf16 v[192:207], v[76:79], v[68:71], v[192:207]
    ds_read_b64_tr_b16 v[100:101], v18 offset:6208
    ds_read_b64_tr_b16 v[102:103], v18 offset:6976
    v_mfma_f32_32x32x16_bf16 v[160:175], v[80:83], v[64:67], v[160:175]
    v_mfma_f32_32x32x16_bf16 v[208:223], v[80:83], v[68:71], v[208:223]
    s_waitcnt lgkmcnt(0)
    v_mfma_f32_32x32x16_bf16 v[128:143], v[92:95], v[84:87], v[128:143]
    ds_read_b128 v[104:107], v15 offset:0
    ds_read_b64_tr_b16 v[112:113], v19 offset:9216
    v_mfma_f32_32x32x16_bf16 v[176:191], v[92:95], v[88:91], v[176:191]
    ds_read_b64_tr_b16 v[114:115], v19 offset:9984
    ds_read_b128 v[108:111], v15 offset:4096
    v_mfma_f32_16x16x32_bf16 v[24:27], v[36:39], v[92:95], v[24:27]
    v_mfma_f32_32x32x16_bf16 v[144:159], v[96:99], v[84:87], v[144:159]
    ds_read_b64_tr_b16 v[116:117], v19 offset:9248
    ds_read_b64_tr_b16 v[118:119], v19 offset:10016
    v_mfma_f32_32x32x16_bf16 v[192:207], v[96:99], v[88:91], v[192:207]
    ds_read_b64_tr_b16 v[120:121], v19 offset:9280
    ds_read_b64_tr_b16 v[122:123], v19 offset:10048
    v_mfma_f32_32x32x16_bf16 v[160:175], v[100:103], v[84:87], v[160:175]
    v_mfma_f32_16x16x32_bf16 v[28:31], v[36:39], v[96:99], v[28:31]
    v_mfma_f32_32x32x16_bf16 v[208:223], v[100:103], v[88:91], v[208:223]
    s_waitcnt lgkmcnt(0)
    s_barrier
    v_mfma_f32_32x32x16_bf16 v[128:143], v[112:115], v[104:107], v[128:143]
    ds_read_b128 v[64:67], v8 offset:0
    ds_read_b64_tr_b16 v[72:73], v16 offset:0
    v_mfma_f32_32x32x16_bf16 v[176:191], v[112:115], v[108:111], v[176:191]
    ds_read_b64_tr_b16 v[74:75], v16 offset:768
    ds_read_b128 v[68:71], v8 offset:4096
    v_mfma_f32_32x32x16_bf16 v[144:159], v[116:119], v[104:107], v[144:159]
    ds_read_b64_tr_b16 v[76:77], v16 offset:32
    ds_read_b64_tr_b16 v[78:79], v16 offset:800
    v_mfma_f32_16x16x32_bf16 v[32:35], v[36:39], v[100:103], v[32:35]
    v_mfma_f32_32x32x16_bf16 v[192:207], v[116:119], v[108:111], v[192:207]
    ds_read_b64_tr_b16 v[80:81], v16 offset:64
    ds_read_b64_tr_b16 v[82:83], v16 offset:832
    v_mfma_f32_32x32x16_bf16 v[160:175], v[120:123], v[104:107], v[160:175]
    v_mfma_f32_32x32x16_bf16 v[208:223], v[120:123], v[108:111], v[208:223]
    s_waitcnt lgkmcnt(0)
    v_mfma_f32_32x32x16_bf16 v[128:143], v[72:75], v[64:67], v[128:143]
    ds_read_b128 v[84:87], v9 offset:0
    ds_read_b64_tr_b16 v[92:93], v17 offset:3072
    v_mfma_f32_32x32x16_bf16 v[176:191], v[72:75], v[68:71], v[176:191]
    ds_read_b64_tr_b16 v[94:95], v17 offset:3840
    ds_read_b128 v[88:91], v9 offset:4096
    v_mfma_f32_16x16x32_bf16 v[24:27], v[36:39], v[72:75], v[24:27]
    v_mfma_f32_32x32x16_bf16 v[144:159], v[76:79], v[64:67], v[144:159]
    ds_read_b64_tr_b16 v[96:97], v17 offset:3104
    ds_read_b64_tr_b16 v[98:99], v17 offset:3872
    v_mfma_f32_32x32x16_bf16 v[192:207], v[76:79], v[68:71], v[192:207]
    ds_read_b64_tr_b16 v[100:101], v17 offset:3136
    ds_read_b64_tr_b16 v[102:103], v17 offset:3904
    v_mfma_f32_32x32x16_bf16 v[160:175], v[80:83], v[64:67], v[160:175]
    v_mfma_f32_16x16x32_bf16 v[28:31], v[36:39], v[76:79], v[28:31]
    v_mfma_f32_32x32x16_bf16 v[208:223], v[80:83], v[68:71], v[208:223]
    s_waitcnt lgkmcnt(0)
    v_mfma_f32_32x32x16_bf16 v[128:143], v[92:95], v[84:87], v[128:143]
    ds_read_b128 v[104:107], v10 offset:0
    ds_read_b64_tr_b16 v[112:113], v16 offset:6144
    v_mfma_f32_32x32x16_bf16 v[176:191], v[92:95], v[88:91], v[176:191]
    ds_read_b64_tr_b16 v[114:115], v16 offset:6912
    ds_read_b128 v[108:111], v10 offset:4096
    v_mfma_f32_32x32x16_bf16 v[144:159], v[96:99], v[84:87], v[144:159]
    ds_read_b64_tr_b16 v[116:117], v16 offset:6176
    ds_read_b64_tr_b16 v[118:119], v16 offset:6944
    v_mfma_f32_16x16x32_bf16 v[32:35], v[36:39], v[80:83], v[32:35]
    v_mfma_f32_32x32x16_bf16 v[192:207], v[96:99], v[88:91], v[192:207]
    ds_read_b64_tr_b16 v[120:121], v16 offset:6208
    ds_read_b64_tr_b16 v[122:123], v16 offset:6976
    v_mfma_f32_32x32x16_bf16 v[160:175], v[100:103], v[84:87], v[160:175]
    v_mfma_f32_32x32x16_bf16 v[208:223], v[100:103], v[88:91], v[208:223]
    s_waitcnt lgkmcnt(0)
    v_mfma_f32_32x32x16_bf16 v[128:143], v[112:115], v[104:107], v[128:143]
    ds_read_b128 v[64:67], v11 offset:0
    ds_read_b64_tr_b16 v[72:73], v17 offset:9216
    v_mfma_f32_16x16x32_bf16 v[24:27], v[36:39], v[112:115], v[24:27]
    v_mfma_f32_32x32x16_bf16 v[176:191], v[112:115], v[108:111], v[176:191]
    ds_read_b64_tr_b16 v[74:75], v17 offset:9984
    ds_read_b128 v[68:71], v11 offset:4096
    v_mfma_f32_16x16x32_bf16 v[28:31], v[36:39], v[116:119], v[28:31]
    v_mfma_f32_32x32x16_bf16 v[144:159], v[116:119], v[104:107], v[144:159]
    ds_read_b64_tr_b16 v[76:77], v17 offset:9248
    ds_read_b64_tr_b16 v[78:79], v17 offset:10016
    v_mfma_f32_16x16x32_bf16 v[32:35], v[36:39], v[120:123], v[32:35]
    v_mfma_f32_32x32x16_bf16 v[192:207], v[116:119], v[108:111], v[192:207]
    ds_read_b64_tr_b16 v[80:81], v17 offset:9280
    ds_read_b64_tr_b16 v[82:83], v17 offset:10048
    v_mfma_f32_32x32x16_bf16 v[160:175], v[120:123], v[104:107], v[160:175]
    v_mfma_f32_32x32x16_bf16 v[208:223], v[120:123], v[108:111], v[208:223]
    v_mov_b32 v60, v24
    v_mov_b32 v61, v28
    s_nop 0
    v_mov_b32 v62, v32
    s_mov_b32 exec_hi, 0
    ds_write_b128 v20, v[60:63]
    s_mov_b32 exec_hi, -1
    s_waitcnt lgkmcnt(0)
    s_barrier
    v_mfma_f32_32x32x16_bf16 v[128:143], v[72:75], v[64:67], v[128:143]
    ds_read_b128 v[84:87], v8 offset:41024
    ds_read_b64_tr_b16 v[92:93], v16 offset:41024
    v_mfma_f32_32x32x16_bf16 v[176:191], v[72:75], v[68:71], v[176:191]
    ds_read_b64_tr_b16 v[94:95], v16 offset:41792
    ds_read_b128 v[88:91], v8 offset:45120
    v_mfma_f32_32x32x16_bf16 v[144:159], v[76:79], v[64:67], v[144:159]
    ds_read_b64_tr_b16 v[96:97], v16 offset:41056
    ds_read_b64_tr_b16 v[98:99], v16 offset:41824
    v_mfma_f32_32x32x16_bf16 v[192:207], v[76:79], v[68:71], v[192:207]
    ds_read_b64_tr_b16 v[100:101], v16 offset:41088
    ds_read_b64_tr_b16 v[102:103], v16 offset:41856
    v_mfma_f32_32x32x16_bf16 v[160:175], v[80:83], v[64:67], v[160:175]
    v_mfma_f32_32x32x16_bf16 v[208:223], v[80:83], v[68:71], v[208:223]
    s_waitcnt lgkmcnt(0)
    v_mfma_f32_32x32x16_bf16 v[128:143], v[92:95], v[84:87], v[128:143]
    ds_read_b128 v[104:107], v9 offset:41024
    ds_read_b64_tr_b16 v[112:113], v17 offset:44096
    v_mfma_f32_32x32x16_bf16 v[176:191], v[92:95], v[88:91], v[176:191]
    ds_read_b64_tr_b16 v[114:115], v17 offset:44864
    ds_read_b128 v[108:111], v9 offset:45120
    v_mfma_f32_16x16x32_bf16 v[24:27], v[36:39], v[92:95], v[24:27]
    v_mfma_f32_32x32x16_bf16 v[144:159], v[96:99], v[84:87], v[144:159]
    ds_read_b64_tr_b16 v[116:117], v17 offset:44128
    ds_read_b64_tr_b16 v[118:119], v17 offset:44896
    v_mfma_f32_32x32x16_bf16 v[192:207], v[96:99], v[88:91], v[192:207]
    ds_read_b64_tr_b16 v[120:121], v17 offset:44160
    ds_read_b64_tr_b16 v[122:123], v17 offset:44928
    v_mfma_f32_16x16x32_bf16 v[28:31], v[36:39], v[96:99], v[28:31]
    v_mfma_f32_32x32x16_bf16 v[160:175], v[100:103], v[84:87], v[160:175]
    v_mfma_f32_16x16x32_bf16 v[32:35], v[36:39], v[100:103], v[32:35]
    v_mfma_f32_32x32x16_bf16 v[208:223], v[100:103], v[88:91], v[208:223]
    s_waitcnt lgkmcnt(0)
    v_mfma_f32_32x32x16_bf16 v[128:143], v[112:115], v[104:107], v[128:143]
    ds_read_b128 v[64:67], v10 offset:41024
    ds_read_b64_tr_b16 v[72:73], v16 offset:47168
    v_mfma_f32_32x32x16_bf16 v[176:191], v[112:115], v[108:111], v[176:191]
    ds_read_b64_tr_b16 v[74:75], v16 offset:47936
    ds_read_b128 v[68:71], v10 offset:45120
    v_mfma_f32_16x16x32_bf16 v[24:27], v[36:39], v[112:115], v[24:27]
    v_mfma_f32_32x32x16_bf16 v[144:159], v[116:119], v[104:107], v[144:159]
    ds_read_b64_tr_b16 v[76:77], v16 offset:47200
    ds_read_b64_tr_b16 v[78:79], v16 offset:47968
    v_mfma_f32_32x32x16_bf16 v[192:207], v[116:119], v[108:111], v[192:207]
    ds_read_b64_tr_b16 v[80:81], v16 offset:47232
    ds_read_b64_tr_b16 v[82:83], v16 offset:48000
    v_mfma_f32_16x16x32_bf16 v[28:31], v[36:39], v[116:119], v[28:31]
    v_mfma_f32_32x32x16_bf16 v[160:175], v[120:123], v[104:107], v[160:175]
    v_mfma_f32_16x16x32_bf16 v[32:35], v[36:39], v[120:123], v[32:35]
    ds_read_b64 v[40:41], v1
    ds_read_b64 v[44:45], v1 offset:256
    ds_read_b128 v[4:7], v21
    v_mfma_f32_32x32x16_bf16 v[208:223], v[120:123], v[108:111], v[208:223]
    s_waitcnt lgkmcnt(0)
    v_mfma_f32_32x32x16_bf16 v[128:143], v[72:75], v[64:67], v[128:143]
    ds_read_b128 v[84:87], v11 offset:41024
    ds_read_b64_tr_b16 v[92:93], v17 offset:50240
    v_cmp_eq_u32 vcc, 0, v7
    s_nop 0
    s_cbranch_vccnz L_lps_4
L_lpd_3:
    v_min_u32 v3, v41, v45
    v_cmp_eq_u32 vcc, 0, v3
    s_nop 0
    s_cbranch_vccnz L_lps_7
L_lpd_6:
    v_mfma_f32_32x32x16_bf16 v[176:191], v[72:75], v[68:71], v[176:191]
    ds_read_b64_tr_b16 v[94:95], v17 offset:51008
    ds_read_b128 v[88:91], v11 offset:45120
    v_mfma_f32_16x16x32_bf16 v[24:27], v[36:39], v[72:75], v[24:27]
    v_rcp_f32 v48, v41
    v_cndmask_b32 v40, 0, v40, s[70:71]
    v_mul_f32 v52, v41, v41
    v_cvt_pk_bf16_f32 v224, v40, v40
    v_cvt_pk_bf16_f32 v225, v40, 0
    v_mul_f32 v50, s69, v48
    v_mfma_f32_32x32x16_bf16 v[144:159], v[76:79], v[64:67], v[144:159]
    ds_read_b64_tr_b16 v[96:97], v17 offset:50272
    ds_read_b64_tr_b16 v[98:99], v17 offset:51040
    v_mul_f32 v49, v48, v48
    v_mul_f32 v48, s68, v48
    v_mov_b32 v51, v50
    v_mul_f32 v48, v48, v49
    v_mov_b32 v53, v52
    v_mov_b32 v49, v48
    v_mfma_f32_32x32x16_bf16 v[192:207], v[76:79], v[68:71], v[192:207]
    ds_read_b64_tr_b16 v[100:101], v17 offset:50304
    ds_read_b64_tr_b16 v[102:103], v17 offset:51072
    v_mfma_f32_16x16x32_bf16 v[28:31], v[36:39], v[76:79], v[28:31]
    v_mfma_f32_32x32x16_bf16 v[160:175], v[80:83], v[64:67], v[160:175]
    v_mfma_f32_16x16x32_bf16 v[32:35], v[36:39], v[80:83], v[32:35]
    v_rcp_f32 v54, v45
    v_cndmask_b32 v44, 0, v44, s[70:71]
    v_mul_f32 v58, v45, v45
    v_cvt_pk_bf16_f32 v228, v44, v44
    v_cvt_pk_bf16_f32 v229, v44, 0
    v_mul_f32 v56, s69, v54
    v_mfma_f32_32x32x16_bf16 v[208:223], v[80:83], v[68:71], v[208:223]
    v_mul_f32 v55, v54, v54
    v_mul_f32 v54, s68, v54
    v_mov_b32 v57, v56
    v_mul_f32 v54, v54, v55
    v_mov_b32 v59, v58
    v_mov_b32 v55, v54
    s_waitcnt lgkmcnt(0)
    v_mfma_f32_16x16x32_bf16 v[24:27], v[36:39], v[92:95], v[24:27]
    v_mfma_f32_16x16x32_bf16 v[28:31], v[36:39], v[96:99], v[28:31]
    v_mfma_f32_16x16x32_bf16 v[32:35], v[36:39], v[100:103], v[32:35]
    v_mfma_f32_32x32x16_bf16 v[128:143], v[92:95], v[84:87], v[128:143]
    v_mfma_f32_32x32x16_bf16 v[176:191], v[92:95], v[88:91], v[176:191]
    v_mfma_f32_32x32x16_bf16 v[144:159], v[96:99], v[84:87], v[144:159]
    s_nop 2
    v_add_f32 v24, v24, v4
    v_cvt_pk_bf16_f32 v25, 0, v24
    v_sub_f32 v26, v24, v25
    v_cvt_pk_bf16_f32 v27, 0, v26
    v_sub_f32 v26, v26, v27
    v_cvt_pk_bf16_f32 v232, v25, v27
    v_cvt_pk_bf16_f32 v233, v26, 0
    v_mfma_f32_32x32x16_bf16 v[192:207], v[96:99], v[88:91], v[192:207]
    v_add_f32 v28, v28, v5
    v_cvt_pk_bf16_f32 v29, 0, v28
    v_sub_f32 v30, v28, v29
    v_cvt_pk_bf16_f32 v31, 0, v30
    v_sub_f32 v30, v30, v31
    v_cvt_pk_bf16_f32 v236, v29, v31
    v_cvt_pk_bf16_f32 v237, v30, 0
    v_mfma_f32_32x32x16_bf16 v[160:175], v[100:103], v[84:87], v[160:175]
    v_add_f32 v32, v32, v6
    v_cvt_pk_bf16_f32 v33, 0, v32
    v_sub_f32 v34, v32, v33
    v_cvt_pk_bf16_f32 v35, 0, v34
    v_sub_f32 v34, v34, v35
    v_cvt_pk_bf16_f32 v240, v33, v35
    v_cvt_pk_bf16_f32 v241, v34, 0
    v_mfma_f32_32x32x16_bf16 v[208:223], v[100:103], v[88:91], v[208:223]
    v_lshlrev_b32 v7, 4, v0
    v_mfma_f32_32x32x16_bf16 v[128:143], v[232:235], v[224:227], v[128:143]
    v_mfma_f32_32x32x16_bf16 v[176:191], v[232:235], v[228:231], v[176:191]
    v_mfma_f32_32x32x16_bf16 v[144:159], v[236:239], v[224:227], v[144:159]
    v_mfma_f32_32x32x16_bf16 v[192:207], v[236:239], v[228:231], v[192:207]
    v_mfma_f32_32x32x16_bf16 v[160:175], v[240:243], v[224:227], v[160:175]
    v_mfma_f32_32x32x16_bf16 v[208:223], v[240:243], v[228:231], v[208:223]
    s_getpc_b64 s[12:13]
    s_mov_b32 s14, 4
    s_mov_b32 s15, 0x00020000
    s_lshl2_add_u32 m0, s11, 163744
    s_mov_b64 exec, 1
    buffer_load_dword v246, s[12:15], 0 offen lds
    s_mov_b64 exec, -1
    v_pk_mul_f32 v[8:9], v[128:129], v[128:129]
    v_pk_mul_f32 v[10:11], v[130:131], v[130:131]
    v_pk_mul_f32 v[12:13], v[132:133], v[132:133]
    v_pk_mul_f32 v[14:15], v[134:135], v[134:135]
    v_pk_fma_f32 v[8:9], v[8:9], v[48:49], v[50:51]
    v_pk_fma_f32 v[10:11], v[10:11], v[48:49], v[50:51]
    v_pk_fma_f32 v[12:13], v[12:13], v[48:49], v[50:51]
    v_pk_fma_f32 v[14:15], v[14:15], v[48:49], v[50:51]
    v_pk_mul_f32 v[8:9], v[8:9], v[128:129]
    v_pk_mul_f32 v[10:11], v[10:11], v[130:131]
    v_pk_mul_f32 v[12:13], v[12:13], v[132:133]
    v_pk_mul_f32 v[14:15], v[14:15], v[134:135]
    v_exp_f32 v8, v8
    v_exp_f32 v9, v9
    v_pk_mul_f32 v[128:129], v[128:129], v[136:137]
    v_exp_f32 v10, v10
    v_exp_f32 v11, v11
    v_pk_mul_f32 v[130:131], v[130:131], v[138:139]
    v_exp_f32 v12, v12
    v_exp_f32 v13, v13
    v_pk_mul_f32 v[132:133], v[132:133], v[140:141]
    v_exp_f32 v14, v14
    v_exp_f32 v15, v15
    v_pk_mul_f32 v[134:135], v[134:135], v[142:143]
    v_pk_fma_f32 v[8:9], v[8:9], v[52:53], v[52:53]
    v_pk_fma_f32 v[10:11], v[10:11], v[52:53], v[52:53]
    v_pk_fma_f32 v[12:13], v[12:13], v[52:53], v[52:53]
    v_pk_fma_f32 v[14:15], v[14:15], v[52:53], v[52:53]
    v_rcp_f32 v8, v8
    v_rcp_f32 v9, v9
    v_rcp_f32 v10, v10
    v_rcp_f32 v11, v11
    v_rcp_f32 v12, v12
    v_rcp_f32 v13, v13
    v_rcp_f32 v14, v14
    v_rcp_f32 v15, v15
    v_pk_mul_f32 v[8:9], v[8:9], v[128:129]
    v_pk_mul_f32 v[10:11], v[10:11], v[130:131]
    v_pk_mul_f32 v[12:13], v[12:13], v[132:133]
    v_pk_mul_f32 v[14:15], v[14:15], v[134:135]
    v_cvt_pk_bf16_f32 v16, v8, v9
    v_cvt_pk_bf16_f32 v17, v10, v11
    v_cvt_pk_bf16_f32 v18, v12, v13
    v_cvt_pk_bf16_f32 v19, v14, v15
    buffer_store_dwordx4 v[16:19], v7, s[60:63], s74 offen offset:0 sc1
    v_pk_mul_f32 v[20:21], v[176:177], v[176:177]
    v_pk_mul_f32 v[22:23], v[178:179], v[178:179]
    v_pk_mul_f32 v[24:25], v[180:181], v[180:181]
    v_pk_mul_f32 v[26:27], v[182:183], v[182:183]
    v_pk_fma_f32 v[20:21], v[20:21], v[54:55], v[56:57]
    v_pk_fma_f32 v[22:23], v[22:23], v[54:55], v[56:57]
    v_pk_fma_f32 v[24:25], v[24:25], v[54:55], v[56:57]
    v_pk_fma_f32 v[26:27], v[26:27], v[54:55], v[56:57]
    v_pk_mul_f32 v[20:21], v[20:21], v[176:177]
    v_pk_mul_f32 v[22:23], v[22:23], v[178:179]
    v_pk_mul_f32 v[24:25], v[24:25], v[180:181]
    v_pk_mul_f32 v[26:27], v[26:27], v[182:183]
    v_exp_f32 v20, v20
    v_exp_f32 v21, v21
    v_pk_mul_f32 v[176:177], v[176:177], v[184:185]
    v_exp_f32 v22, v22
    v_exp_f32 v23, v23
    v_pk_mul_f32 v[178:179], v[178:179], v[186:187]
    v_exp_f32 v24, v24
    v_exp_f32 v25, v25
    v_pk_mul_f32 v[180:181], v[180:181], v[188:189]
    v_exp_f32 v26, v26
    v_exp_f32 v27, v27
    v_pk_mul_f32 v[182:183], v[182:183], v[190:191]
    v_pk_fma_f32 v[20:21], v[20:21], v[58:59], v[58:59]
    v_pk_fma_f32 v[22:23], v[22:23], v[58:59], v[58:59]
    v_pk_fma_f32 v[24:25], v[24:25], v[58:59], v[58:59]
    v_pk_fma_f32 v[26:27], v[26:27], v[58:59], v[58:59]
    v_rcp_f32 v20, v20
    v_rcp_f32 v21, v21
    v_rcp_f32 v22, v22
    v_rcp_f32 v23, v23
    v_rcp_f32 v24, v24
    v_rcp_f32 v25, v25
    v_rcp_f32 v26, v26
    v_rcp_f32 v27, v27
    v_pk_mul_f32 v[20:21], v[20:21], v[176:177]
    v_pk_mul_f32 v[22:23], v[22:23], v[178:179]
    v_pk_mul_f32 v[24:25], v[24:25], v[180:181]
    v_pk_mul_f32 v[26:27], v[26:27], v[182:183]
    v_cvt_pk_bf16_f32 v28, v20, v21
    v_cvt_pk_bf16_f32 v29, v22, v23
    v_cvt_pk_bf16_f32 v30, v24, v25
    v_cvt_pk_bf16_f32 v31, v26, v27
    buffer_store_dwordx4 v[28:31], v7, s[64:67], s74 offen offset:0 sc1
    v_pk_mul_f32 v[8:9], v[144:145], v[144:145]
    v_pk_mul_f32 v[10:11], v[146:147], v[146:147]
    v_pk_mul_f32 v[12:13], v[148:149], v[148:149]
    v_pk_mul_f32 v[14:15], v[150:151], v[150:151]
    v_pk_fma_f32 v[8:9], v[8:9], v[48:49], v[50:51]
    v_pk_fma_f32 v[10:11], v[10:11], v[48:49], v[50:51]
    v_pk_fma_f32 v[12:13], v[12:13], v[48:49], v[50:51]
    v_pk_fma_f32 v[14:15], v[14:15], v[48:49], v[50:51]
    v_pk_mul_f32 v[8:9], v[8:9], v[144:145]
    v_pk_mul_f32 v[10:11], v[10:11], v[146:147]
    v_pk_mul_f32 v[12:13], v[12:13], v[148:149]
    v_pk_mul_f32 v[14:15], v[14:15], v[150:151]
    v_exp_f32 v8, v8
    v_exp_f32 v9, v9
    v_pk_mul_f32 v[144:145], v[144:145], v[152:153]
    v_exp_f32 v10, v10
    v_exp_f32 v11, v11
    v_pk_mul_f32 v[146:147], v[146:147], v[154:155]
    v_exp_f32 v12, v12
    v_exp_f32 v13, v13
    v_pk_mul_f32 v[148:149], v[148:149], v[156:157]
    v_exp_f32 v14, v14
    v_exp_f32 v15, v15
    v_pk_mul_f32 v[150:151], v[150:151], v[158:159]
    v_pk_fma_f32 v[8:9], v[8:9], v[52:53], v[52:53]
    v_pk_fma_f32 v[10:11], v[10:11], v[52:53], v[52:53]
    v_pk_fma_f32 v[12:13], v[12:13], v[52:53], v[52:53]
    v_pk_fma_f32 v[14:15], v[14:15], v[52:53], v[52:53]
    v_rcp_f32 v8, v8
    v_rcp_f32 v9, v9
    v_rcp_f32 v10, v10
    v_rcp_f32 v11, v11
    v_rcp_f32 v12, v12
    v_rcp_f32 v13, v13
    v_rcp_f32 v14, v14
    v_rcp_f32 v15, v15
    v_pk_mul_f32 v[8:9], v[8:9], v[144:145]
    v_pk_mul_f32 v[10:11], v[10:11], v[146:147]
    v_pk_mul_f32 v[12:13], v[12:13], v[148:149]
    v_pk_mul_f32 v[14:15], v[14:15], v[150:151]
    v_cvt_pk_bf16_f32 v16, v8, v9
    v_cvt_pk_bf16_f32 v17, v10, v11
    v_cvt_pk_bf16_f32 v18, v12, v13
    v_cvt_pk_bf16_f32 v19, v14, v15
    buffer_store_dwordx4 v[16:19], v7, s[60:63], s74 offen offset:1024 sc1
    v_pk_mul_f32 v[20:21], v[192:193], v[192:193]
    v_pk_mul_f32 v[22:23], v[194:195], v[194:195]
    v_pk_mul_f32 v[24:25], v[196:197], v[196:197]
    v_pk_mul_f32 v[26:27], v[198:199], v[198:199]
    v_pk_fma_f32 v[20:21], v[20:21], v[54:55], v[56:57]
    v_pk_fma_f32 v[22:23], v[22:23], v[54:55], v[56:57]
    v_pk_fma_f32 v[24:25], v[24:25], v[54:55], v[56:57]
    v_pk_fma_f32 v[26:27], v[26:27], v[54:55], v[56:57]
    v_pk_mul_f32 v[20:21], v[20:21], v[192:193]
    v_pk_mul_f32 v[22:23], v[22:23], v[194:195]
    v_pk_mul_f32 v[24:25], v[24:25], v[196:197]
    v_pk_mul_f32 v[26:27], v[26:27], v[198:199]
    v_exp_f32 v20, v20
    v_exp_f32 v21, v21
    v_pk_mul_f32 v[192:193], v[192:193], v[200:201]
    v_exp_f32 v22, v22
    v_exp_f32 v23, v23
    v_pk_mul_f32 v[194:195], v[194:195], v[202:203]
    v_exp_f32 v24, v24
    v_exp_f32 v25, v25
    v_pk_mul_f32 v[196:197], v[196:197], v[204:205]
    v_exp_f32 v26, v26
    v_exp_f32 v27, v27
    v_pk_mul_f32 v[198:199], v[198:199], v[206:207]
    v_pk_fma_f32 v[20:21], v[20:21], v[58:59], v[58:59]
    v_pk_fma_f32 v[22:23], v[22:23], v[58:59], v[58:59]
    v_pk_fma_f32 v[24:25], v[24:25], v[58:59], v[58:59]
    v_pk_fma_f32 v[26:27], v[26:27], v[58:59], v[58:59]
    v_rcp_f32 v20, v20
    v_rcp_f32 v21, v21
    v_rcp_f32 v22, v22
    v_rcp_f32 v23, v23
    v_rcp_f32 v24, v24
    v_rcp_f32 v25, v25
    v_rcp_f32 v26, v26
    v_rcp_f32 v27, v27
    v_pk_mul_f32 v[20:21], v[20:21], v[192:193]
    v_pk_mul_f32 v[22:23], v[22:23], v[194:195]
    v_pk_mul_f32 v[24:25], v[24:25], v[196:197]
    v_pk_mul_f32 v[26:27], v[26:27], v[198:199]
    v_cvt_pk_bf16_f32 v28, v20, v21
    v_cvt_pk_bf16_f32 v29, v22, v23
    v_cvt_pk_bf16_f32 v30, v24, v25
    v_cvt_pk_bf16_f32 v31, v26, v27
    buffer_store_dwordx4 v[28:31], v7, s[64:67], s74 offen offset:1024 sc1
    v_pk_mul_f32 v[8:9], v[160:161], v[160:161]
    v_pk_mul_f32 v[10:11], v[162:163], v[162:163]
    v_pk_mul_f32 v[12:13], v[164:165], v[164:165]
    v_pk_mul_f32 v[14:15], v[166:167], v[166:167]
    v_pk_fma_f32 v[8:9], v[8:9], v[48:49], v[50:51]
    v_pk_fma_f32 v[10:11], v[10:11], v[48:49], v[50:51]
    v_pk_fma_f32 v[12:13], v[12:13], v[48:49], v[50:51]
    v_pk_fma_f32 v[14:15], v[14:15], v[48:49], v[50:51]
    v_pk_mul_f32 v[8:9], v[8:9], v[160:161]
    v_pk_mul_f32 v[10:11], v[10:11], v[162:163]
    v_pk_mul_f32 v[12:13], v[12:13], v[164:165]
    v_pk_mul_f32 v[14:15], v[14:15], v[166:167]
    v_exp_f32 v8, v8
    v_exp_f32 v9, v9
    v_pk_mul_f32 v[160:161], v[160:161], v[168:169]
    v_exp_f32 v10, v10
    v_exp_f32 v11, v11
    v_pk_mul_f32 v[162:163], v[162:163], v[170:171]
    v_exp_f32 v12, v12
    v_exp_f32 v13, v13
    v_pk_mul_f32 v[164:165], v[164:165], v[172:173]
    v_exp_f32 v14, v14
    v_exp_f32 v15, v15
    v_pk_mul_f32 v[166:167], v[166:167], v[174:175]
    v_pk_fma_f32 v[8:9], v[8:9], v[52:53], v[52:53]
    v_pk_fma_f32 v[10:11], v[10:11], v[52:53], v[52:53]
    v_pk_fma_f32 v[12:13], v[12:13], v[52:53], v[52:53]
    v_pk_fma_f32 v[14:15], v[14:15], v[52:53], v[52:53]
    v_rcp_f32 v8, v8
    v_rcp_f32 v9, v9
    v_rcp_f32 v10, v10
    v_rcp_f32 v11, v11
    v_rcp_f32 v12, v12
    v_rcp_f32 v13, v13
    v_rcp_f32 v14, v14
    v_rcp_f32 v15, v15
    v_pk_mul_f32 v[8:9], v[8:9], v[160:161]
    v_pk_mul_f32 v[10:11], v[10:11], v[162:163]
    v_pk_mul_f32 v[12:13], v[12:13], v[164:165]
    v_pk_mul_f32 v[14:15], v[14:15], v[166:167]
    v_cvt_pk_bf16_f32 v16, v8, v9
    v_cvt_pk_bf16_f32 v17, v10, v11
    v_cvt_pk_bf16_f32 v18, v12, v13
    v_cvt_pk_bf16_f32 v19, v14, v15
    buffer_store_dwordx4 v[16:19], v7, s[60:63], s74 offen offset:2048 sc1
    s_waitcnt vmcnt(3)
    s_mov_b64 exec, 1
    buffer_atomic_add v247, v246, s[56:59], s75 offen offset:0 sc1
    s_mov_b64 exec, -1
    v_pk_mul_f32 v[20:21], v[208:209], v[208:209]
    v_pk_mul_f32 v[22:23], v[210:211], v[210:211]
    v_pk_mul_f32 v[24:25], v[212:213], v[212:213]
    v_pk_mul_f32 v[26:27], v[214:215], v[214:215]
    v_pk_fma_f32 v[20:21], v[20:21], v[54:55], v[56:57]
    v_pk_fma_f32 v[22:23], v[22:23], v[54:55], v[56:57]
    v_pk_fma_f32 v[24:25], v[24:25], v[54:55], v[56:57]
    v_pk_fma_f32 v[26:27], v[26:27], v[54:55], v[56:57]
    v_pk_mul_f32 v[20:21], v[20:21], v[208:209]
    v_pk_mul_f32 v[22:23], v[22:23], v[210:211]
    v_pk_mul_f32 v[24:25], v[24:25], v[212:213]
    v_pk_mul_f32 v[26:27], v[26:27], v[214:215]
    v_exp_f32 v20, v20
    v_exp_f32 v21, v21
    v_pk_mul_f32 v[208:209], v[208:209], v[216:217]
    v_exp_f32 v22, v22
    v_exp_f32 v23, v23
    v_pk_mul_f32 v[210:211], v[210:211], v[218:219]
    v_exp_f32 v24, v24
    v_exp_f32 v25, v25
    v_pk_mul_f32 v[212:213], v[212:213], v[220:221]
    v_exp_f32 v26, v26
    v_exp_f32 v27, v27
    v_pk_mul_f32 v[214:215], v[214:215], v[222:223]
    v_pk_fma_f32 v[20:21], v[20:21], v[58:59], v[58:59]
    v_pk_fma_f32 v[22:23], v[22:23], v[58:59], v[58:59]
    v_pk_fma_f32 v[24:25], v[24:25], v[58:59], v[58:59]
    v_pk_fma_f32 v[26:27], v[26:27], v[58:59], v[58:59]
    v_rcp_f32 v20, v20
    v_rcp_f32 v21, v21
    v_rcp_f32 v22, v22
    v_rcp_f32 v23, v23
    v_rcp_f32 v24, v24
    v_rcp_f32 v25, v25
    v_rcp_f32 v26, v26
    v_rcp_f32 v27, v27
    v_pk_mul_f32 v[20:21], v[20:21], v[208:209]
    v_pk_mul_f32 v[22:23], v[22:23], v[210:211]
    v_pk_mul_f32 v[24:25], v[24:25], v[212:213]
    v_pk_mul_f32 v[26:27], v[26:27], v[214:215]
    v_cvt_pk_bf16_f32 v28, v20, v21
    v_cvt_pk_bf16_f32 v29, v22, v23
    v_cvt_pk_bf16_f32 v30, v24, v25
    v_cvt_pk_bf16_f32 v31, v26, v27
    buffer_store_dwordx4 v[28:31], v7, s[64:67], s74 offen offset:2048 sc1
    v_mov_b32 v57, 0x100
    v_mov_b32 v59, 0x10000
    v_mov_b32 v2, 4
    ds_write_b32 v253, v2
    s_mov_b32 s42, 1048576
    s_nop 1
L_lw_8:
    ds_read_b64 v[60:61], v252 offset:128
    s_waitcnt lgkmcnt(0)
    v_min_u32 v60, v60, v61
    s_nop 0
    v_readfirstlane_b32 s12, v60
    s_nop 0
    s_cmp_ge_u32 s12, 1
    s_cbranch_scc1 L_lwd_9
    s_sub_u32 s42, s42, 1
    s_cmp_lg_u32 s42, 0
    s_sleep 1
    s_cbranch_scc1 L_lw_8
    s_nop 1
L_lwd_9:
L_prefixed:
    ds_read_b64_tr_b16 v[104:105], v248 offset:0
    ds_read_b64_tr_b16 v[106:107], v248 offset:1024
    ds_read_b64_tr_b16 v[108:109], v249 offset:0
    ds_read_b64_tr_b16 v[110:111], v249 offset:1024
    ds_read_b64_tr_b16 v[112:113], v248 offset:2048
    ds_read_b64_tr_b16 v[114:115], v248 offset:3072
    ds_read_b64_tr_b16 v[116:117], v249 offset:2048
    ds_read_b64_tr_b16 v[118:119], v249 offset:3072
    ds_read_b64_tr_b16 v[120:121], v248 offset:4096
    ds_read_b64_tr_b16 v[122:123], v248 offset:5120
    ds_read_b64_tr_b16 v[124:125], v249 offset:4096
    ds_read_b64_tr_b16 v[126:127], v249 offset:5120
    ds_read_b64_tr_b16 v[64:65], v248 offset:6144
    ds_read_b64_tr_b16 v[66:67], v248 offset:7168
    ds_read_b64_tr_b16 v[68:69], v249 offset:6144
    ds_read_b64_tr_b16 v[70:71], v249 offset:7168
    ds_read_b64_tr_b16 v[72:73], v248 offset:8192
    ds_read_b64_tr_b16 v[74:75], v248 offset:9216
    ds_read_b64_tr_b16 v[76:77], v249 offset:8192
    ds_read_b64_tr_b16 v[78:79], v249 offset:9216
    ds_read_b64_tr_b16 v[80:81], v248 offset:10240
    ds_read_b64_tr_b16 v[82:83], v248 offset:11264
    ds_read_b64_tr_b16 v[84:85], v249 offset:10240
    ds_read_b64_tr_b16 v[86:87], v249 offset:11264
    ds_read_b64_tr_b16 v[88:89], v248 offset:12288
    ds_read_b64_tr_b16 v[90:91], v248 offset:13312
    ds_read_b64_tr_b16 v[92:93], v249 offset:12288
    ds_read_b64_tr_b16 v[94:95], v249 offset:13312
    ds_read_b64_tr_b16 v[96:97], v248 offset:14336
    ds_read_b64_tr_b16 v[98:99], v248 offset:15360
    ds_read_b64_tr_b16 v[100:101], v249 offset:14336
    ds_read_b64_tr_b16 v[102:103], v249 offset:15360
    ds_read_b64_tr_b16 v[128:129], v248 offset:16384
    ds_read_b64_tr_b16 v[130:131], v248 offset:17408
    ds_read_b64_tr_b16 v[132:133], v249 offset:16384
    ds_read_b64_tr_b16 v[134:135], v249 offset:17408
    ds_read_b64_tr_b16 v[136:137], v248 offset:18432
    ds_read_b64_tr_b16 v[138:139], v248 offset:19456
    ds_read_b64_tr_b16 v[140:141], v249 offset:18432
    ds_read_b64_tr_b16 v[142:143], v249 offset:19456
    ds_read_b64_tr_b16 v[176:177], v250 offset:0
    ds_read_b64_tr_b16 v[178:179], v250 offset:1024
    ds_read_b64_tr_b16 v[180:181], v251 offset:0
    ds_read_b64_tr_b16 v[182:183], v251 offset:1024
    ds_read_b64_tr_b16 v[184:185], v250 offset:2048
    ds_read_b64_tr_b16 v[186:187], v250 offset:3072
    ds_read_b64_tr_b16 v[188:189], v251 offset:2048
    ds_read_b64_tr_b16 v[190:191], v251 offset:3072
    ds_read_b64_tr_b16 v[144:145], v250 offset:4096
    ds_read_b64_tr_b16 v[146:147], v250 offset:5120
    ds_read_b64_tr_b16 v[148:149], v251 offset:4096
    ds_read_b64_tr_b16 v[150:151], v251 offset:5120
    ds_read_b64_tr_b16 v[152:153], v250 offset:6144
    ds_read_b64_tr_b16 v[154:155], v250 offset:7168
    ds_read_b64_tr_b16 v[156:157], v251 offset:6144
    ds_read_b64_tr_b16 v[158:159], v251 offset:7168
    ds_read_b64_tr_b16 v[192:193], v250 offset:8192
    ds_read_b64_tr_b16 v[194:195], v250 offset:9216
    ds_read_b64_tr_b16 v[196:197], v251 offset:8192
    ds_read_b64_tr_b16 v[198:199], v251 offset:9216
    v_mov_b32 v2, 5
    s_waitcnt lgkmcnt(0)
    ds_write_b32 v253, v2
    s_waitcnt vmcnt(3)
    s_mov_b64 exec, 1
    buffer_atomic_add v57, v246, s[56:59], s75 offen offset:0 sc1
    s_mov_b64 exec, -1
    s_mov_b32 s42, 1048576
    s_nop 1
L_lw_10:
    ds_read_b64 v[60:61], v254 offset:0
    s_waitcnt lgkmcnt(0)
    v_min_u32 v60, v60, v61
    s_nop 0
    v_readfirstlane_b32 s12, v60
    s_nop 0
    s_cmp_ge_u32 s12, 5
    s_cbranch_scc1 L_lwd_11
    s_sub_u32 s42, s42, 1
    s_cmp_lg_u32 s42, 0
    s_cbranch_scc1 L_lw_10
    s_nop 1
L_lwd_11:
    s_add_u32 s13, s72, 32768
    s_add_u32 m0, s73, 82048
    s_nop 0
    buffer_load_dwordx4 v245, s[84:87], s13 offen lds
    s_add_u32 s13, s72, 81920
    s_add_u32 m0, s73, 84096
    s_nop 0
    buffer_load_dwordx4 v245, s[84:87], s13 offen lds
    s_add_u32 s13, s72, 131072
    s_add_u32 m0, s73, 86144
    s_nop 0
    buffer_load_dwordx4 v245, s[84:87], s13 offen lds
    s_add_u32 s13, s72, 180224
    s_add_u32 m0, s73, 88192
    s_nop 0
    buffer_load_dwordx4 v245, s[84:87], s13 offen lds
    v_mov_b32 v62, 0
    s_mov_b64 exec, 1
    buffer_atomic_add v62, v246, s[56:59], s78 offen offset:0 sc0 sc1
    s_mov_b64 exec, -1
    s_add_u32 s13, s72, 229376
    s_add_u32 m0, s73, 90240
    s_nop 0
    buffer_load_dwordx4 v245, s[84:87], s13 offen lds
    s_waitcnt vmcnt(7)
    s_mov_b64 exec, 1
    buffer_atomic_add v59, v246, s[56:59], s75 offen offset:0 sc1
    s_mov_b64 exec, -1
    s_add_u32 s13, s72, 278528
    s_add_u32 m0, s73, 92288
    s_nop 0
    buffer_load_dwordx4 v245, s[84:87], s13 offen lds
    s_add_u32 s13, s72, 327680
    s_add_u32 m0, s73, 94336
    s_nop 0
    buffer_load_dwordx4 v245, s[84:87], s13 offen lds
    s_add_u32 s13, s72, 376832
    s_add_u32 m0, s73, 96384
    s_nop 0
    buffer_load_dwordx4 v245, s[84:87], s13 offen lds
    s_add_u32 s13, s72, 425984
    s_add_u32 m0, s73, 98432
    s_nop 0
    buffer_load_dwordx4 v245, s[84:87], s13 offen lds
    s_add_u32 s13, s72, 475136
    s_add_u32 m0, s73, 100480
    s_nop 0
    buffer_load_dwordx4 v245, s[84:87], s13 offen lds
    s_add_u32 s13, s72, 524288
    s_add_u32 m0, s73, 0
    s_nop 0
    buffer_load_dwordx4 v245, s[84:87], s13 offen lds
    s_add_u32 s13, s72, 573440
    s_add_u32 m0, s73, 2048
    s_nop 0
    buffer_load_dwordx4 v245, s[84:87], s13 offen lds
    s_add_u32 s13, s72, 622592
    s_add_u32 m0, s73, 4096
    s_nop 0
    buffer_load_dwordx4 v245, s[84:87], s13 offen lds
    s_add_u32 s13, s72, 671744
    s_add_u32 m0, s73, 6144
    s_nop 0
    buffer_load_dwordx4 v245, s[84:87], s13 offen lds
    s_add_u32 s13, s72, 720896
    s_add_u32 m0, s73, 8192
    s_nop 0
    buffer_load_dwordx4 v245, s[84:87], s13 offen lds
    s_waitcnt vmcnt(12)
    v_readfirstlane_b32 s12, v62
    s_nop 0
    s_and_b32 s12, s12, 0xff
    s_cmp_ge_u32 s12, 15
    s_cselect_b32 s13, 12500992, s78
    v_mov_b32 v63, 0
    s_mov_b64 exec, 1
    buffer_atomic_add v63, v246, s[56:59], s13 offen offset:0 sc0 sc1
    s_mov_b64 exec, -1
    s_getpc_b64 s[12:13]
    s_mov_b32 s14, 4
    s_mov_b32 s15, 0x00020000
    s_lshl2_add_u32 m0, s11, 163760
    s_mov_b64 exec, 1
    buffer_load_dword v246, s[12:15], 0 offen lds
    s_mov_b64 exec, -1
    s_mov_b32 s42, 1048576
    v_readfirstlane_b32 s12, v62
    s_nop 0
    s_bfe_u32 s70, s12, 0x80008
    s_bfe_u32 s71, s12, 0x80010
    s_and_b32 s12, s12, 0xff
    s_cmp_ge_u32 s12, 15
    s_cbranch_scc1 L_f0d_13
    s_waitcnt vmcnt(1)
    v_mov_b32 v244, v63
    s_branch L_f0f_14
    s_nop 1
L_f0_12:
    v_mov_b32 v244, 0
    s_mov_b64 exec, 1
    buffer_atomic_add v244, v246, s[56:59], s78 offen offset:0 sc0 sc1
    s_mov_b64 exec, -1
    s_waitcnt vmcnt(0)
    s_nop 1
L_f0f_14:
    v_readfirstlane_b32 s12, v244
    s_nop 0
    s_bfe_u32 s70, s12, 0x80008
    s_bfe_u32 s71, s12, 0x80010
    s_and_b32 s12, s12, 0xff
    s_cmp_ge_u32 s12, 15
    s_cbranch_scc1 L_f0d_13
    s_sub_u32 s42, s42, 1
    s_cmp_lg_u32 s42, 0
    s_sleep 2
    s_cbranch_scc1 L_f0_12
    s_nop 1
L_f0d_13:
    s_cmp_ge_u32 s70, 15
    s_cselect_b32 s70, 12500992, s78
    s_cmp_ge_u32 s71, 15
    s_cselect_b32 s71, 12500992, s78
    s_add_u32 s12, s79, 0
    buffer_load_dwordx4 v[160:163], v7, s[80:83], s12 offen sc1
    s_add_u32 s12, s79, 3072
    buffer_load_dwordx4 v[164:167], v7, s[80:83], s12 offen sc1
    s_add_u32 s12, s79, 6144
    buffer_load_dwordx4 v[168:171], v7, s[80:83], s12 offen sc1
    s_add_u32 s12, s79, 9216
    buffer_load_dwordx4 v[172:175], v7, s[80:83], s12 offen sc1
    s_add_u32 s12, s79, 12288
    buffer_load_dwordx4 v[200:203], v7, s[80:83], s12 offen sc1
    s_add_u32 s12, s79, 15360
    buffer_load_dwordx4 v[204:207], v7, s[80:83], s12 offen sc1
    s_add_u32 s12, s79, 18432
    buffer_load_dwordx4 v[208:211], v7, s[80:83], s12 offen sc1
    s_add_u32 s12, s79, 21504
    buffer_load_dwordx4 v[212:215], v7, s[80:83], s12 offen sc1
    s_add_u32 s12, s79, 24576
    buffer_load_dwordx4 v[216:219], v7, s[80:83], s12 offen sc1
    s_add_u32 s12, s79, 27648
    buffer_load_dwordx4 v[220:223], v7, s[80:83], s12 offen sc1
    s_add_u32 s12, s79, 30720
    buffer_load_dwordx4 v[224:227], v7, s[80:83], s12 offen sc1
    s_add_u32 s12, s79, 33792
    buffer_load_dwordx4 v[228:231], v7, s[80:83], s12 offen sc1
    s_nop 1
L_g2go:
    v_mov_b32 v244, 0
    s_mov_b64 exec, 1
    buffer_atomic_add v244, v246, s[56:59], s70 offen offset:0 sc0 sc1
    s_mov_b64 exec, -1
    s_mov_b32 s42, 1048576
    s_nop 1
L_lw_15:
    ds_read_b64 v[2:3], v252 offset:144
    s_waitcnt lgkmcnt(0)
    v_min_u32 v2, v2, v3
    s_nop 0
    v_readfirstlane_b32 s12, v2
    s_nop 0
    s_cmp_ge_u32 s12, 1
    s_cbranch_scc1 L_lwd_16
    s_sub_u32 s42, s42, 1
    s_cmp_lg_u32 s42, 0
    s_cbranch_scc1 L_lw_15
    s_nop 1
L_lwd_16:
    s_add_u32 s12, s79, 36864
    buffer_load_dwordx4 v[232:235], v7, s[80:83], s12 offen sc1
    s_waitcnt vmcnt(13)
    v_mfma_f32_32x32x16_bf16 v[32:47], v[104:107], v[160:163], 0
    v_mfma_f32_32x32x16_bf16 v[48:63], v[108:111], v[160:163], 0
    s_add_u32 s12, s79, 39936
    buffer_load_dwordx4 v[236:239], v7, s[80:83], s12 offen sc1
    s_waitcnt vmcnt(13)
    v_mfma_f32_32x32x16_bf16 v[32:47], v[112:115], v[164:167], v[32:47]
    v_mfma_f32_32x32x16_bf16 v[48:63], v[116:119], v[164:167], v[48:63]
    s_add_u32 s12, s79, 43008
    buffer_load_dwordx4 v[240:243], v7, s[80:83], s12 offen sc1
    s_waitcnt vmcnt(13)
    v_mfma_f32_32x32x16_bf16 v[32:47], v[120:123], v[168:171], v[32:47]
    v_mfma_f32_32x32x16_bf16 v[48:63], v[124:127], v[168:171], v[48:63]
    s_cmp_eq_u32 s70, s78
    s_cbranch_scc1 L_fn_17
L_fnd_18:
    s_add_u32 s12, s79, 1024
    buffer_load_dwordx4 v[160:163], v7, s[80:83], s12 offen sc1
    s_waitcnt vmcnt(13)
    v_mfma_f32_32x32x16_bf16 v[32:47], v[64:67], v[172:175], v[32:47]
    v_mfma_f32_32x32x16_bf16 v[48:63], v[68:71], v[172:175], v[48:63]
    s_add_u32 s12, s79, 4096
    buffer_load_dwordx4 v[164:167], v7, s[80:83], s12 offen sc1
    s_waitcnt vmcnt(13)
    v_mfma_f32_32x32x16_bf16 v[32:47], v[72:75], v[200:203], v[32:47]
    v_mfma_f32_32x32x16_bf16 v[48:63], v[76:79], v[200:203], v[48:63]
    s_add_u32 s12, s79, 7168
    buffer_load_dwordx4 v[168:171], v7, s[80:83], s12 offen sc1
    s_waitcnt vmcnt(13)
    v_mfma_f32_32x32x16_bf16 v[32:47], v[80:83], v[204:207], v[32:47]
    v_mfma_f32_32x32x16_bf16 v[48:63], v[84:87], v[204:207], v[48:63]
    s_add_u32 s12, s79, 10240
    buffer_load_dwordx4 v[172:175], v7, s[80:83], s12 offen sc1
    s_waitcnt vmcnt(13)
    v_mfma_f32_32x32x16_bf16 v[32:47], v[88:91], v[208:211], v[32:47]
    v_mfma_f32_32x32x16_bf16 v[48:63], v[92:95], v[208:211], v[48:63]
    s_add_u32 s12, s79, 13312
    buffer_load_dwordx4 v[200:203], v7, s[80:83], s12 offen sc1
    s_waitcnt vmcnt(13)
    v_mfma_f32_32x32x16_bf16 v[32:47], v[96:99], v[212:215], v[32:47]
    v_mfma_f32_32x32x16_bf16 v[48:63], v[100:103], v[212:215], v[48:63]
    s_add_u32 s12, s79, 16384
    buffer_load_dwordx4 v[204:207], v7, s[80:83], s12 offen sc1
    s_waitcnt vmcnt(13)
    v_mfma_f32_32x32x16_bf16 v[32:47], v[128:131], v[216:219], v[32:47]
    v_mfma_f32_32x32x16_bf16 v[48:63], v[132:135], v[216:219], v[48:63]
    s_add_u32 s12, s79, 19456
    buffer_load_dwordx4 v[208:211], v7, s[80:83], s12 offen sc1
    s_waitcnt vmcnt(13)
    v_mfma_f32_32x32x16_bf16 v[32:47], v[136:139], v[220:223], v[32:47]
    v_mfma_f32_32x32x16_bf16 v[48:63], v[140:143], v[220:223], v[48:63]
    s_add_u32 s12, s79, 22528
    buffer_load_dwordx4 v[212:215], v7, s[80:83], s12 offen sc1
    v_mov_b32 v244, 0
    s_mov_b64 exec, 1
    buffer_atomic_add v244, v246, s[56:59], s71 offen offset:0 sc0 sc1
    s_mov_b64 exec, -1
    s_waitcnt vmcnt(14)
    v_mfma_f32_32x32x16_bf16 v[32:47], v[176:179], v[224:227], v[32:47]
    v_mfma_f32_32x32x16_bf16 v[48:63], v[180:183], v[224:227], v[48:63]
    s_add_u32 s12, s79, 25600
    buffer_load_dwordx4 v[216:219], v7, s[80:83], s12 offen sc1
    s_waitcnt vmcnt(14)
    v_mfma_f32_32x32x16_bf16 v[32:47], v[184:187], v[228:231], v[32:47]
    v_mfma_f32_32x32x16_bf16 v[48:63], v[188:191], v[228:231], v[48:63]
    s_add_u32 s12, s79, 28672
    buffer_load_dwordx4 v[220:223], v7, s[80:83], s12 offen sc1
    s_waitcnt vmcnt(13)
    v_mfma_f32_32x32x16_bf16 v[32:47], v[144:147], v[232:235], v[32:47]
    v_mfma_f32_32x32x16_bf16 v[48:63], v[148:151], v[232:235], v[48:63]
    s_add_u32 s12, s79, 31744
    buffer_load_dwordx4 v[224:227], v7, s[80:83], s12 offen sc1
    s_waitcnt vmcnt(13)
    v_mfma_f32_32x32x16_bf16 v[32:47], v[152:155], v[236:239], v[32:47]
    ds_read_b64_tr_b16 v[8:9], v250 offset:10240
    ds_read_b64_tr_b16 v[10:11], v250 offset:11264
    v_mfma_f32_32x32x16_bf16 v[48:63], v[156:159], v[236:239], v[48:63]
    ds_read_b64_tr_b16 v[12:13], v251 offset:10240
    ds_read_b64_tr_b16 v[14:15], v251 offset:11264
    s_add_u32 s12, s79, 34816
    buffer_load_dwordx4 v[228:231], v7, s[80:83], s12 offen sc1
    s_waitcnt vmcnt(13)
    v_mfma_f32_32x32x16_bf16 v[32:47], v[192:195], v[240:243], v[32:47]
    ds_read_b64_tr_b16 v[16:17], v250 offset:12288
    ds_read_b64_tr_b16 v[18:19], v250 offset:13312
    v_mfma_f32_32x32x16_bf16 v[48:63], v[196:199], v[240:243], v[48:63]
    ds_read_b64_tr_b16 v[20:21], v251 offset:12288
    ds_read_b64_tr_b16 v[22:23], v251 offset:13312
    s_add_u32 s12, s79, 37888
    buffer_load_dwordx4 v[232:235], v7, s[80:83], s12 offen sc1
    s_waitcnt vmcnt(13)
    s_waitcnt lgkmcnt(4)
    v_mfma_f32_32x32x16_bf16 v[32:47], v[8:11], v[160:163], v[32:47]
    ds_read_b64_tr_b16 v[24:25], v250 offset:14336
    ds_read_b64_tr_b16 v[26:27], v250 offset:15360
    v_mfma_f32_32x32x16_bf16 v[48:63], v[12:15], v[160:163], v[48:63]
    ds_read_b64_tr_b16 v[28:29], v251 offset:14336
    ds_read_b64_tr_b16 v[30:31], v251 offset:15360
    s_add_u32 s12, s79, 40960
    buffer_load_dwordx4 v[236:239], v7, s[80:83], s12 offen sc1
    s_waitcnt vmcnt(13)
    s_waitcnt lgkmcnt(4)
    v_mfma_f32_32x32x16_bf16 v[32:47], v[16:19], v[164:167], v[32:47]
    ds_read_b64_tr_b16 v[8:9], v250 offset:16384
    ds_read_b64_tr_b16 v[10:11], v250 offset:17408
    v_mfma_f32_32x32x16_bf16 v[48:63], v[20:23], v[164:167], v[48:63]
    ds_read_b64_tr_b16 v[12:13], v251 offset:16384
    ds_read_b64_tr_b16 v[14:15], v251 offset:17408
    s_add_u32 s12, s79, 44032
    buffer_load_dwordx4 v[240:243], v7, s[80:83], s12 offen sc1
    s_waitcnt vmcnt(13)
    s_waitcnt lgkmcnt(4)
    v_mfma_f32_32x32x16_bf16 v[32:47], v[24:27], v[168:171], v[32:47]
    ds_read_b64_tr_b16 v[16:17], v250 offset:18432
    ds_read_b64_tr_b16 v[18:19], v250 offset:19456
    v_mfma_f32_32x32x16_bf16 v[48:63], v[28:31], v[168:171], v[48:63]
    ds_read_b64_tr_b16 v[20:21], v251 offset:18432
    ds_read_b64_tr_b16 v[22:23], v251 offset:19456
    s_cmp_eq_u32 s71, s78
    s_cbranch_scc1 L_fn_19
L_fnd_20:
    s_add_u32 s12, s79, 2048
    buffer_load_dwordx4 v[160:163], v7, s[80:83], s12 offen sc1
    s_waitcnt vmcnt(13)
    s_waitcnt lgkmcnt(4)
    v_mfma_f32_32x32x16_bf16 v[32:47], v[8:11], v[172:175], v[32:47]
    ds_read_b64_tr_b16 v[24:25], v250 offset:41024
    ds_read_b64_tr_b16 v[26:27], v250 offset:42048
    v_mfma_f32_32x32x16_bf16 v[48:63], v[12:15], v[172:175], v[48:63]
    ds_read_b64_tr_b16 v[28:29], v251 offset:41024
    ds_read_b64_tr_b16 v[30:31], v251 offset:42048
    s_add_u32 s12, s79, 5120
    buffer_load_dwordx4 v[164:167], v7, s[80:83], s12 offen sc1
    s_waitcnt vmcnt(13)
    s_waitcnt lgkmcnt(4)
    v_mfma_f32_32x32x16_bf16 v[32:47], v[16:19], v[200:203], v[32:47]
    ds_read_b64_tr_b16 v[8:9], v250 offset:43072
    ds_read_b64_tr_b16 v[10:11], v250 offset:44096
    v_mfma_f32_32x32x16_bf16 v[48:63], v[20:23], v[200:203], v[48:63]
    ds_read_b64_tr_b16 v[12:13], v251 offset:43072
    ds_read_b64_tr_b16 v[14:15], v251 offset:44096
    s_add_u32 s12, s79, 8192
    buffer_load_dwordx4 v[168:171], v7, s[80:83], s12 offen sc1
    s_waitcnt vmcnt(13)
    s_waitcnt lgkmcnt(4)
    v_mfma_f32_32x32x16_bf16 v[32:47], v[24:27], v[204:207], v[32:47]
    ds_read_b64_tr_b16 v[16:17], v250 offset:45120
    ds_read_b64_tr_b16 v[18:19], v250 offset:46144
    v_mfma_f32_32x32x16_bf16 v[48:63], v[28:31], v[204:207], v[48:63]
    ds_read_b64_tr_b16 v[20:21], v251 offset:45120
    ds_read_b64_tr_b16 v[22:23], v251 offset:46144
    s_add_u32 s12, s79, 11264
    buffer_load_dwordx4 v[172:175], v7, s[80:83], s12 offen sc1
    s_waitcnt vmcnt(13)
    s_waitcnt lgkmcnt(4)
    v_mfma_f32_32x32x16_bf16 v[32:47], v[8:11], v[208:211], v[32:47]
    ds_read_b64_tr_b16 v[24:25], v250 offset:47168
    ds_read_b64_tr_b16 v[26:27], v250 offset:48192
    v_mfma_f32_32x32x16_bf16 v[48:63], v[12:15], v[208:211], v[48:63]
    ds_read_b64_tr_b16 v[28:29], v251 offset:47168
    ds_read_b64_tr_b16 v[30:31], v251 offset:48192
    s_add_u32 s12, s79, 14336
    buffer_load_dwordx4 v[200:203], v7, s[80:83], s12 offen sc1
    s_waitcnt vmcnt(13)
    s_waitcnt lgkmcnt(4)
    v_mfma_f32_32x32x16_bf16 v[32:47], v[16:19], v[212:215], v[32:47]
    ds_read_b64_tr_b16 v[8:9], v250 offset:49216
    ds_read_b64_tr_b16 v[10:11], v250 offset:50240
    v_mfma_f32_32x32x16_bf16 v[48:63], v[20:23], v[212:215], v[48:63]
    ds_read_b64_tr_b16 v[12:13], v251 offset:49216
    ds_read_b64_tr_b16 v[14:15], v251 offset:50240
    s_add_u32 s12, s79, 17408
    buffer_load_dwordx4 v[204:207], v7, s[80:83], s12 offen sc1
    s_waitcnt vmcnt(12)
    s_waitcnt lgkmcnt(4)
    v_mfma_f32_32x32x16_bf16 v[32:47], v[24:27], v[216:219], v[32:47]
    ds_read_b64_tr_b16 v[16:17], v250 offset:51264
    ds_read_b64_tr_b16 v[18:19], v250 offset:52288
    v_mfma_f32_32x32x16_bf16 v[48:63], v[28:31], v[216:219], v[48:63]
    ds_read_b64_tr_b16 v[20:21], v251 offset:51264
    ds_read_b64_tr_b16 v[22:23], v251 offset:52288
    s_add_u32 s12, s79, 20480
    buffer_load_dwordx4 v[208:211], v7, s[80:83], s12 offen sc1
    ds_read_b64 v[68:69], v252 offset:176
    s_waitcnt vmcnt(12)
    s_waitcnt lgkmcnt(5)
    v_mfma_f32_32x32x16_bf16 v[32:47], v[8:11], v[220:223], v[32:47]
    ds_read_b64_tr_b16 v[24:25], v250 offset:53312
    ds_read_b64_tr_b16 v[26:27], v250 offset:54336
    v_mfma_f32_32x32x16_bf16 v[48:63], v[12:15], v[220:223], v[48:63]
    ds_read_b64_tr_b16 v[28:29], v251 offset:53312
    ds_read_b64_tr_b16 v[30:31], v251 offset:54336
    s_add_u32 s12, s79, 23552
    buffer_load_dwordx4 v[212:215], v7, s[80:83], s12 offen sc1
    s_waitcnt vmcnt(12)
    s_waitcnt lgkmcnt(5)
    v_mfma_f32_32x32x16_bf16 v[32:47], v[16:19], v[224:227], v[32:47]
    ds_read_b64_tr_b16 v[8:9], v250 offset:55360
    ds_read_b64_tr_b16 v[10:11], v250 offset:56384
    v_mfma_f32_32x32x16_bf16 v[48:63], v[20:23], v[224:227], v[48:63]
    ds_read_b64_tr_b16 v[12:13], v251 offset:55360
    ds_read_b64_tr_b16 v[14:15], v251 offset:56384
    s_add_u32 s12, s79, 26624
    buffer_load_dwordx4 v[216:219], v7, s[80:83], s12 offen sc1
    s_waitcnt vmcnt(12)
    s_waitcnt lgkmcnt(4)
    v_mfma_f32_32x32x16_bf16 v[32:47], v[24:27], v[228:231], v[32:47]
    ds_read_b64_tr_b16 v[16:17], v250 offset:57408
    ds_read_b64_tr_b16 v[18:19], v250 offset:58432
    v_mfma_f32_32x32x16_bf16 v[48:63], v[28:31], v[228:231], v[48:63]
    ds_read_b64_tr_b16 v[20:21], v251 offset:57408
    ds_read_b64_tr_b16 v[22:23], v251 offset:58432
    s_add_u32 s12, s79, 29696
    buffer_load_dwordx4 v[220:223], v7, s[80:83], s12 offen sc1
    v_min_u32 v68, v68, v69
    s_nop 0
    v_readfirstlane_b32 s12, v68
    s_nop 0
    s_cmp_eq_u32 s12, 0
    s_cbranch_scc1 L_w4_21s
L_w4_21:
    s_waitcnt vmcnt(12)
    s_waitcnt lgkmcnt(4)
    v_mfma_f32_32x32x16_bf16 v[32:47], v[8:11], v[232:235], v[32:47]
    ds_read_b64_tr_b16 v[24:25], v250 offset:59456
    ds_read_b64_tr_b16 v[26:27], v250 offset:60480
    v_mfma_f32_32x32x16_bf16 v[48:63], v[12:15], v[232:235], v[48:63]
    ds_read_b64_tr_b16 v[28:29], v251 offset:59456
    ds_read_b64_tr_b16 v[30:31], v251 offset:60480
    s_add_u32 s12, s79, 32768
    buffer_load_dwordx4 v[224:227], v7, s[80:83], s12 offen sc1
    s_waitcnt vmcnt(12)
    s_waitcnt lgkmcnt(4)
    v_mfma_f32_32x32x16_bf16 v[32:47], v[16:19], v[236:239], v[32:47]
    ds_read_b64_tr_b16 v[8:9], v248 offset:0
    ds_read_b64_tr_b16 v[10:11], v248 offset:1024
    v_mfma_f32_32x32x16_bf16 v[48:63], v[20:23], v[236:239], v[48:63]
    ds_read_b64_tr_b16 v[12:13], v249 offset:0
    ds_read_b64_tr_b16 v[14:15], v249 offset:1024
    s_add_u32 s12, s79, 35840
    buffer_load_dwordx4 v[228:231], v7, s[80:83], s12 offen sc1
    s_waitcnt vmcnt(12)
    s_waitcnt lgkmcnt(4)
    v_mfma_f32_32x32x16_bf16 v[32:47], v[24:27], v[240:243], v[32:47]
    ds_read_b64_tr_b16 v[16:17], v248 offset:2048
    ds_read_b64_tr_b16 v[18:19], v248 offset:3072
    v_mfma_f32_32x32x16_bf16 v[48:63], v[28:31], v[240:243], v[48:63]
    ds_read_b64_tr_b16 v[20:21], v249 offset:2048
    ds_read_b64_tr_b16 v[22:23], v249 offset:3072
    s_add_u32 s12, s79, 38912
    buffer_load_dwordx4 v[232:235], v7, s[80:83], s12 offen sc1
    v_mov_b32 v2, 7
    ds_write_b32 v253, v2
    s_waitcnt vmcnt(12)
    s_waitcnt lgkmcnt(5)
    v_mfma_f32_32x32x16_bf16 v[32:47], v[8:11], v[160:163], v[32:47]
    ds_read_b64_tr_b16 v[24:25], v248 offset:4096
    ds_read_b64_tr_b16 v[26:27], v248 offset:5120
    v_mfma_f32_32x32x16_bf16 v[48:63], v[12:15], v[160:163], v[48:63]
    ds_read_b64_tr_b16 v[28:29], v249 offset:4096
    ds_read_b64_tr_b16 v[30:31], v249 offset:5120
    s_add_u32 s12, s79, 41984
    buffer_load_dwordx4 v[236:239], v7, s[80:83], s12 offen sc1
    s_waitcnt vmcnt(12)
    s_waitcnt lgkmcnt(5)
    v_mfma_f32_32x32x16_bf16 v[32:47], v[16:19], v[164:167], v[32:47]
    ds_read_b64_tr_b16 v[8:9], v248 offset:6144
    ds_read_b64_tr_b16 v[10:11], v248 offset:7168
    v_mfma_f32_32x32x16_bf16 v[48:63], v[20:23], v[164:167], v[48:63]
    ds_read_b64_tr_b16 v[12:13], v249 offset:6144
    ds_read_b64_tr_b16 v[14:15], v249 offset:7168
    s_add_u32 s12, s79, 45056
    buffer_load_dwordx4 v[240:243], v7, s[80:83], s12 offen sc1
    s_waitcnt vmcnt(12)
    s_waitcnt lgkmcnt(4)
    v_mfma_f32_32x32x16_bf16 v[32:47], v[24:27], v[168:171], v[32:47]
    ds_read_b64_tr_b16 v[16:17], v248 offset:8192
    ds_read_b64_tr_b16 v[18:19], v248 offset:9216
    v_mfma_f32_32x32x16_bf16 v[48:63], v[28:31], v[168:171], v[48:63]
    ds_read_b64_tr_b16 v[20:21], v249 offset:8192
    ds_read_b64_tr_b16 v[22:23], v249 offset:9216
    s_waitcnt vmcnt(11)
    s_waitcnt lgkmcnt(4)
    v_mfma_f32_32x32x16_bf16 v[32:47], v[8:11], v[172:175], v[32:47]
    ds_read_b64_tr_b16 v[24:25], v248 offset:10240
    ds_read_b64_tr_b16 v[26:27], v248 offset:11264
    v_mfma_f32_32x32x16_bf16 v[48:63], v[12:15], v[172:175], v[48:63]
    ds_read_b64_tr_b16 v[28:29], v249 offset:10240
    ds_read_b64_tr_b16 v[30:31], v249 offset:11264
    v_and_b32 v4, 31, v0
    v_lshrrev_b32 v5, 5, v0
    v_and_b32 v6, 7, v0
    v_xor_b32 v5, v5, v6
    s_mul_i32 s12, s0, 20480
    s_lshl_b32 s13, s1, 13
    s_add_u32 s12, s12, s13
    s_add_u32 s12, s12, 41024
    v_lshl_add_u32 v4, v4, 8, s12
    s_waitcnt vmcnt(10)
    s_waitcnt lgkmcnt(4)
    v_mfma_f32_32x32x16_bf16 v[32:47], v[16:19], v[200:203], v[32:47]
    ds_read_b64_tr_b16 v[8:9], v248 offset:12288
    ds_read_b64_tr_b16 v[10:11], v248 offset:13312
    v_mfma_f32_32x32x16_bf16 v[48:63], v[20:23], v[200:203], v[48:63]
    ds_read_b64_tr_b16 v[12:13], v249 offset:12288
    ds_read_b64_tr_b16 v[14:15], v249 offset:13312
    v_xor_b32 v6, 0, v5
    v_lshl_add_u32 v64, v6, 4, v4
    v_xor_b32 v6, 2, v5
    v_lshl_add_u32 v65, v6, 4, v4
    s_waitcnt vmcnt(9)
    s_waitcnt lgkmcnt(4)
    v_mfma_f32_32x32x16_bf16 v[32:47], v[24:27], v[204:207], v[32:47]
    ds_read_b64_tr_b16 v[16:17], v248 offset:14336
    ds_read_b64_tr_b16 v[18:19], v248 offset:15360
    v_mfma_f32_32x32x16_bf16 v[48:63], v[28:31], v[204:207], v[48:63]
    ds_read_b64_tr_b16 v[20:21], v249 offset:14336
    ds_read_b64_tr_b16 v[22:23], v249 offset:15360
    v_xor_b32 v6, 4, v5
    v_lshl_add_u32 v66, v6, 4, v4
    v_xor_b32 v6, 6, v5
    v_lshl_add_u32 v67, v6, 4, v4
    s_waitcnt vmcnt(8)
    s_waitcnt lgkmcnt(4)
    v_mfma_f32_32x32x16_bf16 v[32:47], v[8:11], v[208:211], v[32:47]
    ds_read_b64_tr_b16 v[24:25], v248 offset:16384
    ds_read_b64_tr_b16 v[26:27], v248 offset:17408
    v_mfma_f32_32x32x16_bf16 v[48:63], v[12:15], v[208:211], v[48:63]
    ds_read_b64_tr_b16 v[28:29], v249 offset:16384
    ds_read_b64_tr_b16 v[30:31], v249 offset:17408
    s_waitcnt vmcnt(7)
    s_waitcnt lgkmcnt(4)
    v_mfma_f32_32x32x16_bf16 v[32:47], v[16:19], v[212:215], v[32:47]
    ds_read_b64_tr_b16 v[8:9], v248 offset:18432
    ds_read_b64_tr_b16 v[10:11], v248 offset:19456
    v_mfma_f32_32x32x16_bf16 v[48:63], v[20:23], v[212:215], v[48:63]
    ds_read_b64_tr_b16 v[12:13], v249 offset:18432
    ds_read_b64_tr_b16 v[14:15], v249 offset:19456
    s_waitcnt vmcnt(6)
    s_waitcnt lgkmcnt(4)
    v_mfma_f32_32x32x16_bf16 v[32:47], v[24:27], v[216:219], v[32:47]
    ds_read_b64_tr_b16 v[16:17], v250 offset:0
    ds_read_b64_tr_b16 v[18:19], v250 offset:1024
    v_mfma_f32_32x32x16_bf16 v[48:63], v[28:31], v[216:219], v[48:63]
    ds_read_b64_tr_b16 v[20:21], v251 offset:0
    ds_read_b64_tr_b16 v[22:23], v251 offset:1024
    s_waitcnt vmcnt(5)
    s_waitcnt lgkmcnt(4)
    v_mfma_f32_32x32x16_bf16 v[32:47], v[8:11], v[220:223], v[32:47]
    ds_read_b64_tr_b16 v[24:25], v250 offset:2048
    ds_read_b64_tr_b16 v[26:27], v250 offset:3072
    v_mfma_f32_32x32x16_bf16 v[48:63], v[12:15], v[220:223], v[48:63]
    ds_read_b64_tr_b16 v[28:29], v251 offset:2048
    ds_read_b64_tr_b16 v[30:31], v251 offset:3072
    s_waitcnt vmcnt(4)
    s_waitcnt lgkmcnt(4)
    v_mfma_f32_32x32x16_bf16 v[32:47], v[16:19], v[224:227], v[32:47]
    ds_read_b64_tr_b16 v[8:9], v250 offset:4096
    ds_read_b64_tr_b16 v[10:11], v250 offset:5120
    v_mfma_f32_32x32x16_bf16 v[48:63], v[20:23], v[224:227], v[48:63]
    ds_read_b64_tr_b16 v[12:13], v251 offset:4096
    ds_read_b64_tr_b16 v[14:15], v251 offset:5120
    ds_read_b64 v[68:69], v254
    s_waitcnt vmcnt(3)
    s_waitcnt lgkmcnt(5)
    v_mfma_f32_32x32x16_bf16 v[32:47], v[24:27], v[228:231], v[32:47]
    ds_read_b64_tr_b16 v[16:17], v250 offset:6144
    ds_read_b64_tr_b16 v[18:19], v250 offset:7168
    v_mfma_f32_32x32x16_bf16 v[48:63], v[28:31], v[228:231], v[48:63]
    ds_read_b64_tr_b16 v[20:21], v251 offset:6144
    ds_read_b64_tr_b16 v[22:23], v251 offset:7168
    s_waitcnt vmcnt(2)
    s_waitcnt lgkmcnt(5)
    v_mfma_f32_32x32x16_bf16 v[32:47], v[8:11], v[232:235], v[32:47]
    ds_read_b64_tr_b16 v[24:25], v250 offset:8192
    ds_read_b64_tr_b16 v[26:27], v250 offset:9216
    v_mfma_f32_32x32x16_bf16 v[48:63], v[12:15], v[232:235], v[48:63]
    ds_read_b64_tr_b16 v[28:29], v251 offset:8192
    ds_read_b64_tr_b16 v[30:31], v251 offset:9216
    s_waitcnt vmcnt(1)
    s_waitcnt lgkmcnt(4)
    v_mfma_f32_32x32x16_bf16 v[32:47], v[16:19], v[236:239], v[32:47]
    v_mfma_f32_32x32x16_bf16 v[48:63], v[20:23], v[236:239], v[48:63]
    s_waitcnt lgkmcnt(0)
    v_min_u32 v68, v68, v69
    s_nop 0
    v_readfirstlane_b32 s12, v68
    s_nop 0
    s_cmp_lt_u32 s12, 7
    s_cbranch_scc1 L_pp_22s
L_pp_22:
    s_waitcnt vmcnt(0)
    v_mfma_f32_32x32x16_bf16 v[32:47], v[24:27], v[240:243], v[32:47]
    v_mfma_f32_32x32x16_bf16 v[48:63], v[28:31], v[240:243], v[48:63]
    s_nop 10
    ds_write_b128 v64, v[32:35] offset:0
    ds_write_b128 v65, v[36:39] offset:0
    ds_write_b128 v66, v[40:43] offset:0
    ds_write_b128 v67, v[44:47] offset:0
    ds_write_b128 v64, v[48:51] offset:128
    ds_write_b128 v65, v[52:55] offset:128
    ds_write_b128 v66, v[56:59] offset:128
    ds_write_b128 v67, v[60:63] offset:128
    s_waitcnt lgkmcnt(0)
    s_barrier
    s_branch L_fin
.p2align 3
    s_nop 1
L_groupB:
    s_lshr_b32 s12, s5, 2
    s_and_b32 s13, s5, 3
    s_lshr_b32 s8, s4, 1
    s_lshl3_add_u32 s8, s8, s12
    s_and_b32 s9, s4, 1
    s_lshl1_add_u32 s9, s13, s9
    v_lshrrev_b32 v18, 3, v0
    v_and_b32 v19, 7, v0
    v_lshlrev_b32 v20, 10, v18
    v_lshl_add_u32 v20, v19, 4, v20
    s_lshl2_add_u32 s12, s8, s11
    s_lshl_b32 s12, s12, 14
    s_lshl_b32 s13, s9, 7
    s_add_u32 s88, s12, s13
    s_add_u32 s89, s88, 8192
    v_add_u32 v148, s88, v20
    v_subrev_u32 v149, 1024, v148
    v_subrev_u32 v148, 4096, v148
    s_mul_i32 s79, s11, 4736
    s_add_u32 s79, s79, 139456
    v_mov_b32 v192, 0
    v_mov_b32 v193, 0
    v_lshl_add_u32 v8, v0, 3, s79
    ds_write_b64 v8, v[192:193]
    ds_write_b64 v8, v[192:193] offset:2560
    v_lshlrev_b32 v7, 4, v0
    s_lshl3_add_u32 s78, s8, s9
    s_lshl2_add_u32 s78, s78, s11
    s_lshl_b32 s78, s78, 11
    s_lshl_b32 s12, s9, 9
    v_and_b32 v151, 31, v0
    v_lshl_add_u32 v151, v151, 4, s12
    s_mov_b32 s62, 0x200000
    s_mov_b32 s63, 0x00020000
    s_mov_b32 s66, 0x200000
    s_mov_b32 s67, 0x00020000
    s_mov_b32 s70, 0x200000
    s_mov_b32 s71, 0x00020000
    s_add_u32 m0, s79, 512
    s_waitcnt lgkmcnt(0)
    s_mov_b32 s60, s18
    s_mov_b32 s61, s19
    s_mov_b32 s64, s20
    s_mov_b32 s65, s21
    s_mov_b32 s68, s16
    s_mov_b32 s69, s17
    s_mov_b32 s14, s78
    s_mov_b32 s15, s79
    s_lshr_b32 s12, s5, 2
    s_and_b32 s13, s5, 3
    s_lshr_b32 s8, s4, 1
    s_lshl3_add_u32 s8, s8, s12
    s_and_b32 s9, s4, 1
    s_lshl1_add_u32 s9, s13, s9
    s_lshr_b32 s0, s11, 1
    s_and_b32 s1, s11, 1
    v_lshlrev_b32 v7, 4, v0
    s_mov_b32 s56, s40
    s_mov_b32 s57, s41
    s_mov_b32 s58, 12500992
    s_mov_b32 s59, 0x00020000
    v_lshrrev_b32 v8, 3, v0
    v_and_b32 v9, 7, v0
    v_lshrrev_b32 v10, 4, v0
    v_xor_b32 v11, v9, v10
    v_lshlrev_b32 v11, 4, v11
    v_lshl_add_u32 v2, v8, 10, v11
    v_xor_b32 v11, 64, v11
    v_lshl_add_u32 v3, v8, 10, v11
    v_add_u32 v3, 8192, v3
    s_lshl2_add_u32 s48, s6, s11
    s_lshl_b32 s48, s48, 15
    s_lshl_b32 s50, s11, 12
    s_cmp_eq_u32 s7, 15
    s_cselect_b32 s46, 0, 0x200000
    s_mov_b32 s47, 0x00020000
    s_mov_b32 s12, 0x15555556
    v_mul_hi_u32 v9, v0, s12
    v_mul_u32_u24 v10, 2560, v9
    v_lshl_add_u32 v4, v0, 4, v10
    v_add_u32 v8, 64, v0
    v_mul_hi_u32 v9, v8, s12
    v_mul_u32_u24 v10, 2560, v9
    v_lshl_add_u32 v5, v8, 4, v10
    v_add_u32 v8, 128, v0
    v_mul_hi_u32 v9, v8, s12
    v_mul_u32_u24 v10, 2560, v9
    v_lshl_add_u32 v6, v8, 4, v10
    s_lshr_b32 s12, s11, 1
    s_mul_i32 s49, s12, 88064
    s_mul_i32 s13, s7, 192
    s_add_u32 s49, s49, s13
    s_mul_i32 s51, s12, 6144
    s_and_b32 s13, s11, 1
    s_mul_i32 s13, s13, 12320
    s_add_u32 s51, s51, s13
    s_add_u32 s51, s51, 16384
    s_cmp_eq_u32 s7, 15
    s_cselect_b32 s54, 0, 1409024
    s_mov_b32 s55, 0x00020000
    s_mov_b32 s44, s16
    s_mov_b32 s45, s17
    s_bitcmp1_b32 s3, 0
    s_cselect_b32 s52, s32, s30
    s_cselect_b32 s53, s33, s31
    v_mov_b32 v194, 0
    v_mov_b32 v195, 0
    s_lshl_b32 s12, s11, 10
    s_add_u32 s12, s12, 158400
    v_add_u32 v8, s12, v7
    ds_write_b128 v8, v[192:195]
    v_add_u32 v8, 162496, v7
    ds_write_b128 v8, v[192:195]
    v_lshlrev_b32 v9, 2, v0
    v_add_u32 v9, 163584, v9
    ds_write_b32 v9, v192
    s_mov_b32 s80, s34
    s_mov_b32 s81, s35
    s_mov_b32 s82, 1409024
    s_mov_b32 s83, 0x00020000
    s_lshl_b32 s12, s2, 1
    s_add_u32 s12, s12, s0
    s_lshl_b32 s13, s12, 1
    v_mov_b32 v8, s13
    s_mul_i32 s13, s12, 8192
    s_add_u32 s13, s13, 5636096
    s_lshl_b32 s12, s12, 12
    s_add_u32 s84, s40, s13
    s_addc_u32 s85, s41, 0
    s_mov_b32 s86, 8192
    s_mov_b32 s87, 0x00020000
    s_add_u32 s28, s24, s12
    s_addc_u32 s29, s25, 0
    s_mov_b32 s30, 4096
    s_mov_b32 s31, 0x00020000
    v_lshrrev_b32 v144, 5, v0
    v_and_b32 v145, 31, v0
    v_lshlrev_b32 v146, 10, v144
    v_lshl_add_u32 v146, v145, 2, v146
    v_add_u32 v146, s79, v146
    v_add_u32 v147, 1024, v146
    v_add_u32 v150, 2560, v146
    s_mul_i32 s43, s0, 17664
    s_add_u32 s43, s43, 123072
    v_mov_b32 v215, 0
    v_mov_b32 v254, 1
    s_mul_i32 s12, s1, 4220
    s_add_u32 s12, s12, s43
    s_add_u32 s33, s12, 64
    v_mov_b32 v9, s33
    s_and_b32 s12, s11, 1
    s_lshl_b32 s12, s12, 3
    s_lshl_b32 s13, s0, 1
    s_add_u32 s12, s12, s13
    v_lshl_add_u32 v152, v144, 2, s12
    v_and_b32 v210, 7, v145
    v_lshlrev_b32 v210, 1, v210
    v_xor_b32 v152, v152, v210
    v_lshlrev_b32 v152, 4, v152
    v_lshl_add_u32 v152, v145, 9, v152
    v_add_u32 v152, 123072, v152
    s_lshl_b32 s12, s11, 12
    s_add_u32 s12, s12, 123072
    v_add_u32 v153, s12, v7
    v_lshrrev_b32 v210, 4, v0
    v_and_b32 v211, 15, v0
    v_lshrrev_b32 v212, 5, v0
    v_lshlrev_b32 v212, 1, v212
    v_xor_b32 v211, v211, v212
    v_lshlrev_b32 v210, 13, v210
    v_xor_b32 v212, 0, v211
    v_lshl_add_u32 v154, v212, 4, v210
    v_xor_b32 v212, 4, v211
    v_lshl_add_u32 v155, v212, 4, v210
    v_xor_b32 v212, 8, v211
    v_lshl_add_u32 v156, v212, 4, v210
    v_xor_b32 v212, 12, v211
    v_lshl_add_u32 v157, v212, 4, v210
    s_lshl_b32 s12, s9, 6
    s_lshl_b32 s13, s11, 4
    s_add_u32 s12, s12, s13
    s_lshl_b32 s12, s12, 13
    s_lshl_b32 s13, s8, 8
    s_add_u32 s12, s12, s13
    s_add_u32 s16, s12, 5636096
    s_lshl_b32 s12, s11, 2
    s_add_u32 s13, s12, 163584
    v_mov_b32 v22, s13
    s_add_u32 s13, s12, 163616
    v_mov_b32 v23, s13
    v_mov_b32 v252, 163616
    v_mov_b32 v253, 163600
    v_bfe_u32 v210, v0, 4, 1
    v_lshlrev_b32 v210, 2, v210
    v_xor_b32 v210, v19, v210
    v_lshlrev_b32 v210, 4, v210
    v_lshl_add_u32 v12, v18, 10, v210
    s_mul_i32 s78, s0, 737280
    s_lshl_b32 s12, s1, 13
    s_add_u32 s78, s78, s12
    s_lshl_b32 s12, s9, 7
    s_add_u32 s78, s78, s12
    s_mul_i32 s79, s0, 20480
    s_lshl_b32 s12, s1, 10
    s_add_u32 s79, s79, s12
    s_lshl_b32 s12, s8, 10
    s_lshl_b32 s13, s11, 8
    s_add_u32 s12, s12, s13
    s_add_u32 s18, s12, 11927552
    v_lshlrev_b32 v21, 4, v18
    s_lshr_b32 s12, s2, 3
    s_lshl_b32 s12, s12, 7
    s_add_u32 s19, s12, 11968512
    s_lshr_b32 s12, s5, 2
    s_lshl_b32 s12, s12, 2
    s_add_u32 s12, s12, s11
    s_mul_i32 s12, s12, 45056
    s_lshl_b32 s13, s9, 7
    s_add_u32 s73, s12, s13
    v_lshlrev_b32 v249, 10, v0
    v_and_b32 v10, 31, v0
    s_lshl_b32 s12, s11, 8
    s_add_u32 s12, s12, 162496
    v_lshl_add_u32 v11, v10, 3, s12
    v_lshlrev_b32 v10, 4, v10
    s_lshl_b32 s12, s6, 11
    s_lshl_b32 s13, s11, 9
    s_add_u32 s12, s12, s13
    s_add_u32 s32, s12, 11927552
    s_lshr_b32 s12, s2, 5
    s_lshl_b32 s12, s12, 2
    s_add_u32 s12, s12, s11
    s_lshl_b32 s12, s12, 7
    s_add_u32 s34, s12, 11972608
    s_lshl_b32 s12, s9, 2
    s_lshr_b32 s13, s8, 3
    s_add_u32 s12, s12, s13
    s_lshl_b32 s12, s12, 7
    s_add_u32 s35, s12, 11972608
    v_and_b32 v214, 3, v0
    v_bfe_u32 v210, v0, 2, 2
    v_lshrrev_b32 v211, 4, v0
    v_lshlrev_b32 v214, 4, v214
    v_lshl_add_u32 v214, v210, 8, v214
    v_lshl_add_u32 v214, v211, 6, v214
    s_lshl_b32 s12, s1, 12
    v_add_u32 v214, s12, v214
    s_add_u32 s12, s12, s43
    s_add_u32 s72, s12, 9472
    v_and_b32 v210, 15, v0
    v_and_b32 v212, 1, v0
    v_lshlrev_b32 v13, 2, v210
    v_lshlrev_b32 v213, 4, v211
    v_sub_u32 v13, v13, v213
    v_xor_b32 v213, 1, v212
    v_mul_u32_u24 v213, 4220, v213
    s_lshl_b32 s12, s1, 8
    s_add_u32 s12, s12, s43
    s_add_u32 s12, s12, 52
    v_add3_u32 v13, v13, v213, s12
    v_lshrrev_b32 v210, 1, v210
    v_lshlrev_b32 v211, 8, v211
    v_lshl_add_u32 v211, v212, 4, v211
    s_add_u32 s12, s43, 8448
    v_add_u32 v211, s12, v211
    s_lshl_b32 s12, s1, 2
    s_sub_u32 s12, 8, s12
    v_add_u32 v210, s12, v210
    v_subrev_u32 v212, 0, v210
    v_lshrrev_b32 v213, 3, v212
    v_and_b32 v212, 7, v212
    v_lshl_add_u32 v213, v213, 10, v211
    v_lshl_add_u32 v14, v212, 5, v213
    v_subrev_u32 v212, 1, v210
    v_lshrrev_b32 v213, 3, v212
    v_and_b32 v212, 7, v212
    v_lshl_add_u32 v213, v213, 10, v211
    v_lshl_add_u32 v15, v212, 5, v213
    v_subrev_u32 v212, 2, v210
    v_lshrrev_b32 v213, 3, v212
    v_and_b32 v212, 7, v212
    v_lshl_add_u32 v213, v213, 10, v211
    v_lshl_add_u32 v16, v212, 5, v213
    v_subrev_u32 v212, 3, v210
    v_lshrrev_b32 v213, 3, v212
    v_and_b32 v212, 7, v212
    v_lshl_add_u32 v213, v213, 10, v211
    v_lshl_add_u32 v17, v212, 5, v213
    s_setprio 2
    s_waitcnt lgkmcnt(0)
    s_barrier
    buffer_load_dwordx4 v[60:63], v7, s[68:71], s14 offen
    buffer_load_dwordx4 v[64:67], v7, s[68:71], s14 offen offset:1024
    global_load_dwordx2 v[58:59], v215, s[38:39] sc1
    s_add_u32 m0, s15, 512
    s_nop 0
    buffer_load_dwordx4 v20, s[60:63], s88 offen nt lds
    s_add_u32 m0, s15, 1536
    s_nop 0
    buffer_load_dwordx4 v20, s[60:63], s89 offen nt lds
    s_add_u32 m0, s15, 2688
    s_nop 0
    buffer_load_dwordx4 v20, s[64:67], s88 offen nt lds
    s_add_u32 m0, s15, 3712
    s_nop 0
    buffer_load_dwordx4 v20, s[64:67], s89 offen nt lds
    s_mov_b32 m0, s15
    s_mov_b32 exec_hi, 0
    buffer_load_dwordx4 v148, s[60:63], 0 offen nt lds
    s_add_u32 m0, s15, 2560
    s_mov_b32 exec_lo, 0xff
    buffer_load_dwordx4 v149, s[64:67], 0 offen nt lds
    s_mov_b64 exec, -1
    global_load_dwordx4 v[54:57], v151, s[22:23]
    s_barrier
    s_cmp_eq_u32 s7, 15
    s_cbranch_scc1 L_idleB
    s_add_u32 s12, s10, 2
    s_and_b32 s12, s12, 7
    s_lshl_b32 s74, s12, 7
    s_add_u32 s74, s74, s48
    s_mul_i32 s75, s12, 176128
    s_add_u32 s75, s75, s49
    s_add_u32 m0, s50, 82048
    s_nop 0
    buffer_load_dwordx4 v2, s[44:47], s74 offen lds
    s_add_u32 m0, s50, 83072
    s_nop 0
    buffer_load_dwordx4 v3, s[44:47], s74 offen lds
    s_add_u32 s74, s74, 16384
    s_add_u32 m0, s50, 84096
    s_nop 0
    buffer_load_dwordx4 v2, s[44:47], s74 offen lds
    s_add_u32 m0, s50, 85120
    s_nop 0
    buffer_load_dwordx4 v3, s[44:47], s74 offen lds
    s_waitcnt vmcnt(12)
    v_lshlrev_b32 v160, 16, v60
    v_and_b32 v161, 0xffff0000, v60
    v_lshlrev_b32 v162, 16, v61
    v_and_b32 v163, 0xffff0000, v61
    v_lshlrev_b32 v164, 16, v62
    v_and_b32 v165, 0xffff0000, v62
    v_lshlrev_b32 v166, 16, v63
    v_and_b32 v167, 0xffff0000, v63
    v_lshlrev_b32 v168, 16, v64
    v_and_b32 v169, 0xffff0000, v64
    v_lshlrev_b32 v170, 16, v65
    v_and_b32 v171, 0xffff0000, v65
    v_lshlrev_b32 v172, 16, v66
    v_and_b32 v173, 0xffff0000, v66
    v_lshlrev_b32 v174, 16, v67
    v_and_b32 v175, 0xffff0000, v67
    v_add_f32 v176, v160, v161
    v_add_f32 v177, v168, v169
    v_add_f32 v176, v176, v162
    v_add_f32 v177, v177, v170
    v_add_f32 v176, v176, v163
    v_add_f32 v177, v177, v171
    v_add_f32 v176, v176, v164
    v_add_f32 v177, v177, v172
    v_add_f32 v176, v176, v165
    v_add_f32 v177, v177, v173
    v_add_f32 v176, v176, v166
    v_add_f32 v177, v177, v174
    v_add_f32 v176, v176, v167
    v_add_f32 v177, v177, v175
    s_nop 0
    v_add_f32_dpp v176, v176, v176 row_shr:1 row_mask:0xf bank_mask:0xf
    v_add_f32_dpp v177, v177, v177 row_shr:1 row_mask:0xf bank_mask:0xf
    s_nop 0
    v_add_f32_dpp v176, v176, v176 row_shr:2 row_mask:0xf bank_mask:0xf
    v_add_f32_dpp v177, v177, v177 row_shr:2 row_mask:0xf bank_mask:0xf
    s_nop 0
    v_add_f32_dpp v176, v176, v176 row_shr:4 row_mask:0xf bank_mask:0xf
    v_add_f32_dpp v177, v177, v177 row_shr:4 row_mask:0xf bank_mask:0xf
    s_nop 0
    v_add_f32_dpp v176, v176, v176 row_shr:8 row_mask:0xf bank_mask:0xf
    v_add_f32_dpp v177, v177, v177 row_shr:8 row_mask:0xf bank_mask:0xf
    s_nop 0
    v_add_f32_dpp v176, v176, v176 row_bcast:15 row_mask:0xa bank_mask:0xf
    v_add_f32_dpp v177, v177, v177 row_bcast:15 row_mask:0xa bank_mask:0xf
    s_nop 0
    v_add_f32_dpp v176, v176, v176 row_bcast:31 row_mask:0xc bank_mask:0xf
    v_add_f32_dpp v177, v177, v177 row_bcast:31 row_mask:0xc bank_mask:0xf
    v_readlane_b32 s17, v176, 63
    v_readlane_b32 s20, v177, 63
    v_mov_b32 v178, 0x3b000000
    v_mul_f32 v180, s17, v178
    v_mul_f32 v181, s20, v178
    v_sub_f32 v160, v160, v180
    v_sub_f32 v168, v168, v181
    v_sub_f32 v161, v161, v180
    v_sub_f32 v169, v169, v181
    v_sub_f32 v162, v162, v180
    v_sub_f32 v170, v170, v181
    v_sub_f32 v163, v163, v180
    v_sub_f32 v171, v171, v181
    v_sub_f32 v164, v164, v180
    v_sub_f32 v172, v172, v181
    v_sub_f32 v165, v165, v180
    v_sub_f32 v173, v173, v181
    v_sub_f32 v166, v166, v180
    v_sub_f32 v174, v174, v181
    v_sub_f32 v167, v167, v180
    v_sub_f32 v175, v175, v181
    v_mul_f32 v176, v160, v160
    v_mul_f32 v177, v168, v168
    v_fmac_f32 v176, v161, v161
    v_fmac_f32 v177, v169, v169
    v_fmac_f32 v176, v162, v162
    v_fmac_f32 v177, v170, v170
    v_fmac_f32 v176, v163, v163
    v_fmac_f32 v177, v171, v171
    v_fmac_f32 v176, v164, v164
    v_fmac_f32 v177, v172, v172
    v_fmac_f32 v176, v165, v165
    v_fmac_f32 v177, v173, v173
    v_fmac_f32 v176, v166, v166
    v_fmac_f32 v177, v174, v174
    v_fmac_f32 v176, v167, v167
    v_fmac_f32 v177, v175, v175
    s_nop 0
    v_add_f32_dpp v176, v176, v176 row_shr:1 row_mask:0xf bank_mask:0xf
    v_add_f32_dpp v177, v177, v177 row_shr:1 row_mask:0xf bank_mask:0xf
    s_nop 0
    v_add_f32_dpp v176, v176, v176 row_shr:2 row_mask:0xf bank_mask:0xf
    v_add_f32_dpp v177, v177, v177 row_shr:2 row_mask:0xf bank_mask:0xf
    s_nop 0
    v_add_f32_dpp v176, v176, v176 row_shr:4 row_mask:0xf bank_mask:0xf
    v_add_f32_dpp v177, v177, v177 row_shr:4 row_mask:0xf bank_mask:0xf
    s_nop 0
    v_add_f32_dpp v176, v176, v176 row_shr:8 row_mask:0xf bank_mask:0xf
    v_add_f32_dpp v177, v177, v177 row_shr:8 row_mask:0xf bank_mask:0xf
    s_nop 0
    v_add_f32_dpp v176, v176, v176 row_bcast:15 row_mask:0xa bank_mask:0xf
    v_add_f32_dpp v177, v177, v177 row_bcast:15 row_mask:0xa bank_mask:0xf
    s_nop 0
    v_add_f32_dpp v176, v176, v176 row_bcast:31 row_mask:0xc bank_mask:0xf
    v_add_f32_dpp v177, v177, v177 row_bcast:31 row_mask:0xc bank_mask:0xf
    v_readlane_b32 s17, v176, 63
    v_readlane_b32 s20, v177, 63
    v_cmp_eq_u32 vcc, 0, v0
    s_nop 0
    v_mov_b32 v176, s20
    v_mov_b32 v177, s17
    v_cndmask_b32 v176, v176, v177, vcc
    v_cndmask_b32 v180, v181, v180, vcc
    v_mul_f32 v176, v176, v178
    v_cvt_pk_bf16_f32 v176, 0, v176
    v_add_f32 v176, 0x3727c5ac, v176
    v_cvt_pk_bf16_f32 v176, 0, v176
    v_sqrt_f32 v176, v176
    v_cvt_pk_bf16_f32 v180, 0, v180
    v_cvt_pk_bf16_f32 v185, 0, v176
    v_xor_b32 v184, 0x80000000, v180
    s_mov_b32 s42, 1048576
    s_waitcnt vmcnt(11)
    s_branch L_noncef_25
    s_nop 1
L_nonce_23:
    v_mov_b32 v58, 0
    global_load_dwordx2 v[58:59], v58, s[38:39] sc1
    s_waitcnt vmcnt(0)
    s_nop 1
L_noncef_25:
    v_readfirstlane_b32 s76, v58
    v_readfirstlane_b32 s77, v59
    s_nop 0
    s_and_b32 s12, s76, s77
    s_bitcmp1_b32 s12, 0
    s_cbranch_scc1 L_nonced_24
    s_sub_u32 s42, s42, 1
    s_cmp_lg_u32 s42, 0
    s_cbranch_scc1 L_nonce_23
    s_nop 1
L_nonced_24:
    s_waitcnt vmcnt(4)
    ds_read2_b32 v[32:33], v146 offset0:0 offset1:32
    ds_read2_b32 v[34:35], v146 offset0:64 offset1:96
    ds_read2_b32 v[36:37], v146 offset0:128 offset1:160
    ds_read2_b32 v[38:39], v146 offset0:192 offset1:224
    ds_read2_b32 v[40:41], v147 offset0:0 offset1:32
    ds_read2_b32 v[42:43], v147 offset0:64 offset1:96
    ds_read2_b32 v[44:45], v150 offset0:0 offset1:32
    ds_read2_b32 v[46:47], v150 offset0:64 offset1:96
    ds_read2_b32 v[48:49], v150 offset0:128 offset1:160
    ds_read2_b32 v[50:51], v150 offset0:192 offset1:224
    ds_read_b32 v52, v150 offset:1024
    s_add_u32 m0, s51, 82048
    s_nop 0
    buffer_load_dwordx4 v4, s[52:55], s75 offen lds
    v_lshlrev_b32 v96, 16, v54
    v_lshlrev_b32 v97, 16, v56
    s_add_u32 m0, s51, 83072
    s_nop 0
    buffer_load_dwordx4 v5, s[52:55], s75 offen lds
    v_and_b32 v98, 0xffff0000, v54
    v_and_b32 v99, 0xffff0000, v56
    s_add_u32 m0, s51, 84096
    s_nop 0
    buffer_load_dwordx4 v6, s[52:55], s75 offen lds
    v_lshlrev_b32 v100, 16, v55
    v_lshlrev_b32 v101, 16, v57
    s_add_u32 s75, s75, 44032
    s_add_u32 m0, s51, 85120
    s_nop 0
    buffer_load_dwordx4 v4, s[52:55], s75 offen lds
    v_and_b32 v102, 0xffff0000, v55
    v_and_b32 v103, 0xffff0000, v57
    s_add_u32 m0, s51, 86144
    s_nop 0
    buffer_load_dwordx4 v5, s[52:55], s75 offen lds
    s_waitcnt lgkmcnt(5)
    v_lshlrev_b32 v70, 16, v32
    s_add_u32 m0, s51, 87168
    s_nop 0
    buffer_load_dwordx4 v6, s[52:55], s75 offen lds
    v_and_b32 v71, 0xffff0000, v32
    v_lshlrev_b32 v72, 16, v33
    s_add_u32 s12, s10, 3
    s_and_b32 s12, s12, 7
    s_lshl_b32 s74, s12, 7
    s_add_u32 s74, s74, s48
    s_mul_i32 s75, s12, 176128
    s_add_u32 s75, s75, s49
    v_and_b32 v73, 0xffff0000, v33
    v_lshlrev_b32 v74, 16, v34
    v_and_b32 v75, 0xffff0000, v34
    v_lshlrev_b32 v76, 16, v35
    v_and_b32 v77, 0xffff0000, v35
    v_lshlrev_b32 v78, 16, v36
    v_and_b32 v79, 0xffff0000, v36
    v_lshlrev_b32 v80, 16, v37
    s_add_u32 m0, s50, 0
    s_nop 0
    buffer_load_dwordx4 v2, s[44:47], s74 offen lds
    v_and_b32 v81, 0xffff0000, v37
    v_lshlrev_b32 v82, 16, v38
    v_and_b32 v83, 0xffff0000, v38
    v_lshlrev_b32 v84, 16, v39
    v_and_b32 v85, 0xffff0000, v39
    v_lshlrev_b32 v86, 16, v40
    v_and_b32 v87, 0xffff0000, v40
    v_lshlrev_b32 v88, 16, v41
    s_add_u32 m0, s50, 1024
    s_nop 0
    buffer_load_dwordx4 v3, s[44:47], s74 offen lds
    v_and_b32 v89, 0xffff0000, v41
    v_lshlrev_b32 v90, 16, v42
    v_and_b32 v91, 0xffff0000, v42
    v_lshlrev_b32 v92, 16, v43
    v_and_b32 v93, 0xffff0000, v43
    v_mul_f32 v104, v70, v102
    v_mul_f32 v105, v71, v103
    v_mul_f32 v106, v72, v102
    s_add_u32 s74, s74, 16384
    s_add_u32 m0, s50, 2048
    s_nop 0
    buffer_load_dwordx4 v2, s[44:47], s74 offen lds
    v_mul_f32 v107, v73, v103
    v_mul_f32 v108, v74, v102
    v_mul_f32 v109, v75, v103
    v_mul_f32 v110, v76, v102
    v_mul_f32 v111, v77, v103
    v_mul_f32 v112, v78, v102
    v_mul_f32 v113, v79, v103
    v_mul_f32 v114, v80, v102
    s_add_u32 m0, s50, 3072
    s_nop 0
    buffer_load_dwordx4 v3, s[44:47], s74 offen lds
    v_mul_f32 v115, v81, v103
    v_mul_f32 v116, v82, v102
    v_mul_f32 v117, v83, v103
    v_mul_f32 v118, v84, v102
    v_mul_f32 v119, v85, v103
    v_mul_f32 v120, v86, v102
    v_mul_f32 v121, v87, v103
    v_fmac_f32 v104, v72, v100
    s_add_u32 m0, s51, 0
    s_waitcnt vmcnt(13)
    buffer_load_dwordx4 v4, s[52:55], s75 offen lds
    v_fmac_f32 v105, v73, v101
    v_fmac_f32 v106, v74, v100
    v_fmac_f32 v107, v75, v101
    v_fmac_f32 v108, v76, v100
    v_fmac_f32 v109, v77, v101
    v_fmac_f32 v110, v78, v100
    v_fmac_f32 v111, v79, v101
    v_fmac_f32 v112, v80, v100
    s_add_u32 m0, s51, 1024
    s_waitcnt vmcnt(13)
    buffer_load_dwordx4 v5, s[52:55], s75 offen lds
    v_fmac_f32 v113, v81, v101
    v_fmac_f32 v114, v82, v100
    v_fmac_f32 v115, v83, v101
    v_fmac_f32 v116, v84, v100
    v_fmac_f32 v117, v85, v101
    v_fmac_f32 v118, v86, v100
    v_fmac_f32 v119, v87, v101
    v_fmac_f32 v120, v88, v100
    s_add_u32 m0, s51, 2048
    s_waitcnt vmcnt(13)
    buffer_load_dwordx4 v6, s[52:55], s75 offen lds
    v_fmac_f32 v121, v89, v101
    v_fmac_f32 v104, v74, v98
    v_fmac_f32 v105, v75, v99
    v_fmac_f32 v106, v76, v98
    v_fmac_f32 v107, v77, v99
    v_fmac_f32 v108, v78, v98
    v_fmac_f32 v109, v79, v99
    v_fmac_f32 v110, v80, v98
    s_add_u32 s75, s75, 44032
    s_add_u32 m0, s51, 3072
    s_waitcnt vmcnt(13)
    buffer_load_dwordx4 v4, s[52:55], s75 offen lds
    v_fmac_f32 v111, v81, v99
    v_fmac_f32 v112, v82, v98
    v_fmac_f32 v113, v83, v99
    v_fmac_f32 v114, v84, v98
    v_fmac_f32 v115, v85, v99
    v_fmac_f32 v116, v86, v98
    v_fmac_f32 v117, v87, v99
    v_fmac_f32 v118, v88, v98
    s_add_u32 m0, s51, 4096
    s_waitcnt vmcnt(13)
    buffer_load_dwordx4 v5, s[52:55], s75 offen lds
    v_fmac_f32 v119, v89, v99
    v_fmac_f32 v120, v90, v98
    v_fmac_f32 v121, v91, v99
    v_fmac_f32 v104, v76, v96
    v_fmac_f32 v105, v77, v97
    v_fmac_f32 v106, v78, v96
    v_fmac_f32 v107, v79, v97
    v_fmac_f32 v108, v80, v96
    s_add_u32 m0, s51, 5120
    s_waitcnt vmcnt(13)
    buffer_load_dwordx4 v6, s[52:55], s75 offen lds
    v_fmac_f32 v109, v81, v97
    v_fmac_f32 v110, v82, v96
    v_fmac_f32 v111, v83, v97
    v_fmac_f32 v112, v84, v96
    v_fmac_f32 v113, v85, v97
    v_fmac_f32 v114, v86, v96
    v_fmac_f32 v115, v87, v97
    v_fmac_f32 v116, v88, v96
    v_mov_b32 v186, s76
    v_mov_b32 v187, s77
    s_lshl_b32 s12, s8, 10
    s_lshl_b32 s13, s9, 7
    s_add_u32 s12, s12, s13
    s_lshl_b32 s13, s11, 5
    s_add_u32 s12, s12, s13
    s_add_u32 s12, s12, 11927552
    s_mov_b64 exec, 3
    s_waitcnt vmcnt(13)
    buffer_store_dwordx4 v[184:187], v7, s[56:59], s12 offen sc1
    s_mov_b64 exec, -1
    s_waitcnt vmcnt(11)
    s_barrier
    s_add_u32 s12, s10, 4
    s_and_b32 s12, s12, 7
    s_lshl_b32 s74, s12, 7
    s_add_u32 s74, s74, s48
    s_mul_i32 s75, s12, 176128
    s_add_u32 s75, s75, s49
    v_fmac_f32 v117, v89, v97
    v_fmac_f32 v118, v90, v96
    v_fmac_f32 v119, v91, v97
    v_fmac_f32 v120, v92, v96
    v_fmac_f32 v121, v93, v97
    s_waitcnt lgkmcnt(0)
    v_lshlrev_b32 v70, 16, v44
    v_and_b32 v71, 0xffff0000, v44
    s_add_u32 m0, s50, 41024
    s_nop 0
    buffer_load_dwordx4 v2, s[44:47], s74 offen lds
    v_lshlrev_b32 v72, 16, v45
    v_and_b32 v73, 0xffff0000, v45
    v_lshlrev_b32 v74, 16, v46
    v_and_b32 v75, 0xffff0000, v46
    v_lshlrev_b32 v76, 16, v47
    v_and_b32 v77, 0xffff0000, v47
    v_lshlrev_b32 v78, 16, v48
    v_and_b32 v79, 0xffff0000, v48
    s_add_u32 m0, s50, 42048
    s_nop 0
    buffer_load_dwordx4 v3, s[44:47], s74 offen lds
    v_lshlrev_b32 v80, 16, v49
    v_and_b32 v81, 0xffff0000, v49
    v_lshlrev_b32 v82, 16, v50
    v_and_b32 v83, 0xffff0000, v50
    v_lshlrev_b32 v84, 16, v51
    v_and_b32 v85, 0xffff0000, v51
    v_lshlrev_b32 v86, 16, v52
    v_and_b32 v87, 0xffff0000, v52
    s_add_u32 s74, s74, 16384
    s_add_u32 m0, s50, 43072
    s_nop 0
    buffer_load_dwordx4 v2, s[44:47], s74 offen lds
    v_mul_f32 v104, v104, v70
    v_mul_f32 v105, v105, v71
    v_mul_f32 v106, v106, v72
    v_mul_f32 v107, v107, v73
    v_mul_f32 v108, v108, v74
    v_mul_f32 v109, v109, v75
    v_mul_f32 v110, v110, v76
    v_mul_f32 v111, v111, v77
    s_add_u32 m0, s50, 44096
    s_waitcnt vmcnt(13)
    buffer_load_dwordx4 v3, s[44:47], s74 offen lds
    v_mul_f32 v112, v112, v78
    v_mul_f32 v113, v113, v79
    v_mul_f32 v114, v114, v80
    v_mul_f32 v115, v115, v81
    v_mul_f32 v116, v116, v82
    v_mul_f32 v117, v117, v83
    v_mul_f32 v118, v118, v84
    v_mul_f32 v119, v119, v85
    s_add_u32 m0, s51, 41024
    s_waitcnt vmcnt(13)
    buffer_load_dwordx4 v4, s[52:55], s75 offen lds
    v_mul_f32 v120, v120, v86
    v_mul_f32 v121, v121, v87
    v_cvt_pk_bf16_f32 v124, v118, v116
    v_cvt_pk_bf16_f32 v125, v114, v112
    v_cvt_pk_bf16_f32 v126, v110, v108
    v_cvt_pk_bf16_f32 v127, v106, v104
    v_cvt_pk_bf16_f32 v128, v120, v118
    v_cvt_pk_bf16_f32 v129, v116, v114
    s_add_u32 m0, s51, 42048
    s_waitcnt vmcnt(13)
    buffer_load_dwordx4 v5, s[52:55], s75 offen lds
    v_cvt_pk_bf16_f32 v130, v112, v110
    v_cvt_pk_bf16_f32 v131, v108, v106
    v_cvt_pk_bf16_f32 v132, v119, v117
    v_cvt_pk_bf16_f32 v133, v115, v113
    v_cvt_pk_bf16_f32 v134, v111, v109
    v_cvt_pk_bf16_f32 v135, v107, v105
    v_cvt_pk_bf16_f32 v136, v121, v119
    v_cvt_pk_bf16_f32 v137, v117, v115
    s_add_u32 m0, s51, 43072
    s_waitcnt vmcnt(13)
    buffer_load_dwordx4 v6, s[52:55], s75 offen lds
    v_cvt_pk_bf16_f32 v138, v113, v111
    v_cvt_pk_bf16_f32 v139, v109, v107
    s_add_u32 s75, s75, 44032
    s_add_u32 m0, s51, 44096
    s_waitcnt vmcnt(13)
    buffer_load_dwordx4 v4, s[52:55], s75 offen lds
    s_add_u32 m0, s51, 45120
    s_waitcnt vmcnt(13)
    buffer_load_dwordx4 v5, s[52:55], s75 offen lds
    s_add_u32 m0, s51, 46144
    s_waitcnt vmcnt(13)
    buffer_load_dwordx4 v6, s[52:55], s75 offen lds
    ds_write_b128 v152, v[124:127] offset:0
    ds_write_b128 v152, v[128:131] offset:16
    ds_write_b128 v152, v[132:135] offset:256
    ds_write_b128 v152, v[136:139] offset:272
    s_waitcnt vmcnt(11)
    s_waitcnt lgkmcnt(0)
    s_barrier
    ds_read_b128 v[124:127], v153 offset:0
    ds_read_b128 v[128:131], v153 offset:1024
    ds_read_b128 v[132:135], v153 offset:2048
    ds_read_b128 v[136:139], v153 offset:3072
    s_add_u32 s12, s10, 5
    s_and_b32 s12, s12, 7
    s_lshl_b32 s74, s12, 7
    s_add_u32 s74, s74, s48
    s_mul_i32 s75, s12, 176128
    s_add_u32 s75, s75, s49
    s_add_u32 m0, s50, 82048
    s_nop 0
    buffer_load_dwordx4 v2, s[44:47], s74 offen lds
    s_add_u32 m0, s50, 83072
    s_nop 0
    buffer_load_dwordx4 v3, s[44:47], s74 offen lds
    s_add_u32 s74, s74, 16384
    s_add_u32 m0, s50, 84096
    s_nop 0
    buffer_load_dwordx4 v2, s[44:47], s74 offen lds
    s_add_u32 m0, s50, 85120
    s_waitcnt vmcnt(13)
    buffer_load_dwordx4 v3, s[44:47], s74 offen lds
    s_add_u32 m0, s51, 82048
    s_waitcnt vmcnt(13)
    buffer_load_dwordx4 v4, s[52:55], s75 offen lds
    s_add_u32 m0, s51, 83072
    s_waitcnt vmcnt(13)
    buffer_load_dwordx4 v5, s[52:55], s75 offen lds
    s_add_u32 m0, s51, 84096
    s_waitcnt vmcnt(13)
    buffer_load_dwordx4 v6, s[52:55], s75 offen lds
    s_add_u32 s75, s75, 44032
    s_add_u32 m0, s51, 85120
    s_waitcnt vmcnt(13)
    buffer_load_dwordx4 v4, s[52:55], s75 offen lds
    s_add_u32 m0, s51, 86144
    s_waitcnt vmcnt(13)
    buffer_load_dwordx4 v5, s[52:55], s75 offen lds
    s_add_u32 m0, s51, 87168
    s_waitcnt vmcnt(13)
    buffer_load_dwordx4 v6, s[52:55], s75 offen lds
    s_waitcnt lgkmcnt(3)
    s_add_u32 s13, s16, 0
    s_waitcnt vmcnt(13)
    buffer_store_dwordx4 v[124:127], v154, s[56:59], s13 offen sc1
    s_waitcnt lgkmcnt(2)
    s_add_u32 s13, s16, 32768
    s_waitcnt vmcnt(13)
    buffer_store_dwordx4 v[128:131], v155, s[56:59], s13 offen sc1
    s_waitcnt lgkmcnt(1)
    s_add_u32 s13, s16, 65536
    s_waitcnt vmcnt(13)
    buffer_store_dwordx4 v[132:135], v156, s[56:59], s13 offen sc1
    s_waitcnt lgkmcnt(0)
    s_add_u32 s13, s16, 98304
    s_waitcnt vmcnt(13)
    buffer_store_dwordx4 v[136:139], v157, s[56:59], s13 offen sc1
    s_waitcnt lgkmcnt(0)
    s_barrier
    s_add_u32 s12, s10, 6
    s_and_b32 s12, s12, 7
    s_lshl_b32 s74, s12, 7
    s_add_u32 s74, s74, s48
    s_mul_i32 s75, s12, 176128
    s_add_u32 s75, s75, s49
    s_add_u32 m0, s50, 0
    s_waitcnt vmcnt(13)
    buffer_load_dwordx4 v2, s[44:47], s74 offen lds
    s_add_u32 m0, s50, 1024
    s_waitcnt vmcnt(13)
    buffer_load_dwordx4 v3, s[44:47], s74 offen lds
    s_add_u32 s74, s74, 16384
    s_add_u32 m0, s50, 2048
    s_waitcnt vmcnt(13)
    buffer_load_dwordx4 v2, s[44:47], s74 offen lds
    s_add_u32 m0, s50, 3072
    s_waitcnt vmcnt(13)
    buffer_load_dwordx4 v3, s[44:47], s74 offen lds
    s_add_u32 m0, s51, 0
    s_waitcnt vmcnt(13)
    buffer_load_dwordx4 v4, s[52:55], s75 offen lds
    s_add_u32 m0, s51, 1024
    s_waitcnt vmcnt(13)
    buffer_load_dwordx4 v5, s[52:55], s75 offen lds
    s_add_u32 m0, s51, 2048
    s_waitcnt vmcnt(13)
    buffer_load_dwordx4 v6, s[52:55], s75 offen lds
    s_add_u32 s75, s75, 44032
    s_add_u32 m0, s51, 3072
    s_waitcnt vmcnt(13)
    buffer_load_dwordx4 v4, s[52:55], s75 offen lds
    s_add_u32 m0, s51, 4096
    s_waitcnt vmcnt(13)
    buffer_load_dwordx4 v5, s[52:55], s75 offen lds
    s_add_u32 m0, s51, 5120
    s_waitcnt vmcnt(13)
    buffer_load_dwordx4 v6, s[52:55], s75 offen lds
    s_lshl_b32 s12, s9, 2
    s_add_u32 s12, s12, s11
    s_lshl_b32 s12, s12, 7
    s_add_u32 s13, s12, 11968512
    s_waitcnt vmcnt(10)
    s_mov_b64 exec, 1
    buffer_atomic_add v254, v215, s[56:59], s13 offen offset:0 sc1
    s_mov_b64 exec, -1
    s_waitcnt lgkmcnt(0)
    s_barrier
    s_add_u32 s12, s10, 7
    s_and_b32 s12, s12, 7
    s_lshl_b32 s74, s12, 7
    s_add_u32 s74, s74, s48
    s_mul_i32 s75, s12, 176128
    s_add_u32 s75, s75, s49
    s_add_u32 m0, s50, 41024
    s_nop 0
    buffer_load_dwordx4 v2, s[44:47], s74 offen lds
    s_add_u32 m0, s50, 42048
    s_nop 0
    buffer_load_dwordx4 v3, s[44:47], s74 offen lds
    s_add_u32 s74, s74, 16384
    s_add_u32 m0, s50, 43072
    s_nop 0
    buffer_load_dwordx4 v2, s[44:47], s74 offen lds
    s_add_u32 m0, s50, 44096
    s_waitcnt vmcnt(13)
    buffer_load_dwordx4 v3, s[44:47], s74 offen lds
    s_add_u32 m0, s51, 41024
    s_waitcnt vmcnt(13)
    buffer_load_dwordx4 v4, s[52:55], s75 offen lds
    s_add_u32 m0, s51, 42048
    s_waitcnt vmcnt(13)
    buffer_load_dwordx4 v5, s[52:55], s75 offen lds
    s_add_u32 m0, s51, 43072
    s_waitcnt vmcnt(13)
    buffer_load_dwordx4 v6, s[52:55], s75 offen lds
    s_add_u32 s75, s75, 44032
    s_add_u32 m0, s51, 44096
    s_waitcnt vmcnt(13)
    buffer_load_dwordx4 v4, s[52:55], s75 offen lds
    s_add_u32 m0, s51, 45120
    s_waitcnt vmcnt(13)
    buffer_load_dwordx4 v5, s[52:55], s75 offen lds
    s_add_u32 m0, s51, 46144
    s_waitcnt vmcnt(13)
    buffer_load_dwordx4 v6, s[52:55], s75 offen lds
    s_waitcnt vmcnt(13)
    buffer_load_dwordx4 v[200:203], v21, s[56:59], s18 offen sc1
    s_waitcnt vmcnt(13)
    buffer_load_dwordx4 v[204:207], v21, s[56:59], s18 offen offset:128 sc1
    s_waitcnt vmcnt(13)
    buffer_load_dwordx4 v[196:199], v10, s[56:59], s32 offen sc1
    s_add_u32 s42, s2, 3
    s_and_b32 s42, s42, 7
    s_lshl3_add_u32 s42, s5, s42
    s_lshl2_add_u32 s42, s42, s11
    s_lshl_b32 s42, s42, 11
    s_mov_b32 s12, s24
    s_mov_b32 s13, s25
    s_mov_b32 s14, 0x200000
    s_mov_b32 s15, 0x00020000
    v_lshlrev_b32 v249, 7, v0
    s_mov_b64 exec, 0xffff
    s_waitcnt vmcnt(13)
    buffer_load_dword v248, v249, s[12:15], s42 offen
    s_mov_b64 exec, -1
    s_waitcnt lgkmcnt(0)
    s_barrier
    s_mov_b32 m0, s33
    s_waitcnt vmcnt(13)
    buffer_load_dwordx4 v7, s[28:31], 0 offen offset:0 lds
    s_waitcnt vmcnt(13)
    buffer_load_dwordx4 v7, s[28:31], 0 offen offset:1024 lds
    s_waitcnt vmcnt(13)
    buffer_load_dwordx4 v7, s[28:31], 0 offen offset:2048 lds
    s_waitcnt vmcnt(13)
    buffer_load_dwordx4 v7, s[28:31], 0 offen offset:3072 lds
    s_waitcnt vmcnt(13)
    global_load_ushort v8, v8, s[26:27]
    s_add_u32 s13, s78, 0
    s_add_u32 m0, s79, 82048
    s_waitcnt vmcnt(13)
    buffer_load_dwordx4 v12, s[80:83], s13 offen lds
    s_add_u32 s13, s78, 49152
    s_add_u32 m0, s79, 84096
    s_waitcnt vmcnt(13)
    buffer_load_dwordx4 v12, s[80:83], s13 offen lds
    s_add_u32 s13, s78, 98304
    s_add_u32 m0, s79, 86144
    s_waitcnt vmcnt(13)
    buffer_load_dwordx4 v12, s[80:83], s13 offen lds
    s_add_u32 s13, s78, 147456
    s_add_u32 m0, s79, 88192
    s_waitcnt vmcnt(13)
    buffer_load_dwordx4 v12, s[80:83], s13 offen lds
    s_mov_b32 s42, 1048576
    s_waitcnt vmcnt(10)
    s_branch L_pfirst_28
    s_nop 1
L_poll_26:
    buffer_load_dwordx4 v[200:203], v21, s[56:59], s18 offen sc1
    buffer_load_dwordx4 v[204:207], v21, s[56:59], s18 offen offset:128 sc1
    buffer_load_dwordx4 v[196:199], v10, s[56:59], s32 offen sc1
    s_waitcnt vmcnt(0)
    s_nop 1
L_pfirst_28:
    v_cmp_ne_u64 vcc, s[76:77], v[202:203]
    s_nop 0
    s_mov_b64 s[12:13], vcc
    v_cmp_ne_u64 vcc, s[76:77], v[206:207]
    s_nop 0
    s_or_b64 s[12:13], s[12:13], vcc
    v_cmp_ne_u64 vcc, s[76:77], v[198:199]
    s_nop 0
    s_or_b64 s[12:13], s[12:13], vcc
    s_cmp_eq_u64 s[12:13], 0
    s_cbranch_scc1 L_pdone_27
    s_sub_u32 s42, s42, 1
    s_cmp_lg_u32 s42, 0
    s_sleep 4
    s_cbranch_scc1 L_poll_26
    s_nop 1
L_pdone_27:
    ds_write_b64 v11, v[196:197]
    s_barrier
    s_mul_i32 s12, s1, 4224
    s_add_u32 m0, s12, s43
    s_lshr_b32 exec_lo, 0xffff, s1
    s_mov_b32 exec_hi, 0
    s_mov_b32 s13, 12500992
    buffer_load_dword v215, s[56:59], s13 offen lds
    s_lshl_b32 s12, s1, 9
    s_add_u32 s12, s12, s43
    s_mov_b32 exec_lo, -1
    s_add_u32 m0, s12, 8448
    s_nop 0
    buffer_load_dwordx4 v215, s[56:59], s13 offen lds
    s_mov_b64 exec, -1
    s_add_u32 s13, s78, 196608
    s_add_u32 m0, s79, 90240
    s_waitcnt vmcnt(10)
    buffer_load_dwordx4 v12, s[80:83], s13 offen lds
    s_add_u32 s13, s78, 245760
    s_add_u32 m0, s79, 92288
    s_waitcnt vmcnt(10)
    buffer_load_dwordx4 v12, s[80:83], s13 offen lds
    s_add_u32 s13, s78, 294912
    s_add_u32 m0, s79, 94336
    s_waitcnt vmcnt(10)
    buffer_load_dwordx4 v12, s[80:83], s13 offen lds
    s_add_u32 s13, s78, 344064
    s_add_u32 m0, s79, 96384
    s_waitcnt vmcnt(10)
    buffer_load_dwordx4 v12, s[80:83], s13 offen lds
    s_add_u32 s13, s78, 393216
    s_add_u32 m0, s79, 98432
    s_waitcnt vmcnt(10)
    buffer_load_dwordx4 v12, s[80:83], s13 offen lds
    s_add_u32 s13, s78, 442368
    s_add_u32 m0, s79, 100480
    s_waitcnt vmcnt(10)
    buffer_load_dwordx4 v12, s[80:83], s13 offen lds
    s_getpc_b64 s[12:13]
    s_mov_b32 s14, 4
    s_mov_b32 s15, 0x00020000
    s_lshl2_add_u32 m0, s11, 163696
    s_mov_b64 exec, 1
    s_waitcnt vmcnt(10)
    buffer_load_dword v215, s[12:15], 0 offen lds
    s_mov_b64 exec, -1
    s_add_u32 s13, s78, 491520
    s_add_u32 m0, s79, 0
    s_waitcnt vmcnt(10)
    buffer_load_dwordx4 v12, s[80:83], s13 offen lds
    s_add_u32 s13, s78, 540672
    s_add_u32 m0, s79, 2048
    s_waitcnt vmcnt(10)
    buffer_load_dwordx4 v12, s[80:83], s13 offen lds
    s_add_u32 s13, s78, 589824
    s_add_u32 m0, s79, 4096
    s_waitcnt vmcnt(10)
    buffer_load_dwordx4 v12, s[80:83], s13 offen lds
    s_add_u32 s13, s78, 638976
    s_add_u32 m0, s79, 6144
    s_waitcnt vmcnt(10)
    buffer_load_dwordx4 v12, s[80:83], s13 offen lds
    v_mov_b32 v208, 0
    s_mov_b64 exec, 1
    s_waitcnt vmcnt(10)
    buffer_atomic_add v208, v215, s[56:59], s19 offen offset:0 sc0 sc1
    s_mov_b64 exec, -1
    s_add_u32 s13, s78, 688128
    s_add_u32 m0, s79, 8192
    s_waitcnt vmcnt(10)
    buffer_load_dwordx4 v12, s[80:83], s13 offen lds
    s_add_u32 s13, s78, 16384
    s_add_u32 m0, s79, 10240
    s_waitcnt vmcnt(10)
    buffer_load_dwordx4 v12, s[80:83], s13 offen lds
    s_add_u32 s13, s78, 65536
    s_add_u32 m0, s79, 12288
    s_waitcnt vmcnt(10)
    buffer_load_dwordx4 v12, s[80:83], s13 offen lds
    s_add_u32 s13, s78, 114688
    s_add_u32 m0, s79, 14336
    s_waitcnt vmcnt(10)
    buffer_load_dwordx4 v12, s[80:83], s13 offen lds
    s_add_u32 s13, s78, 163840
    s_add_u32 m0, s79, 16384
    s_waitcnt vmcnt(10)
    buffer_load_dwordx4 v12, s[80:83], s13 offen lds
    s_add_u32 s13, s78, 212992
    s_add_u32 m0, s79, 18432
    s_waitcnt vmcnt(10)
    buffer_load_dwordx4 v12, s[80:83], s13 offen lds
    s_getpc_b64 s[12:13]
    s_mov_b32 s14, 4
    s_mov_b32 s15, 0x00020000
    s_lshl2_add_u32 m0, s11, 163712
    s_mov_b64 exec, 1
    s_waitcnt vmcnt(10)
    buffer_load_dword v215, s[12:15], 0 offen lds
    s_mov_b64 exec, -1
    ds_read_u16 v210, v9
    s_waitcnt lgkmcnt(0)
    v_lshlrev_b32 v210, 16, v210
    v_lshlrev_b32 v8, 16, v8
    v_add_f32 v8, v8, v210
    v_cvt_pk_bf16_f32 v8, v8, 0
    ds_write_b16 v9, v8
    s_mov_b32 s42, 1048576
    s_waitcnt vmcnt(7)
    s_branch L_cwf_31
    s_nop 1
L_cw_29:
    v_mov_b32 v208, 0
    s_mov_b64 exec, 1
    buffer_atomic_add v208, v215, s[56:59], s19 offen offset:0 sc0 sc1
    s_mov_b64 exec, -1
    s_waitcnt vmcnt(0)
    s_nop 1
L_cwf_31:
    v_readfirstlane_b32 s12, v208
    s_nop 0
    s_cmp_ge_u32 s12, 32
    s_cbranch_scc1 L_cwd_30
    s_sub_u32 s42, s42, 1
    s_cmp_lg_u32 s42, 0
    s_sleep 4
    s_cbranch_scc1 L_cw_29
    s_nop 1
L_cwd_30:
    s_mov_b32 m0, s72
    s_nop 0
    buffer_load_dwordx4 v214, s[84:87], 0 offen offset:0 sc1 lds
    buffer_load_dwordx4 v214, s[84:87], 0 offen offset:1024 sc1 lds
    buffer_load_dwordx4 v214, s[84:87], 0 offen offset:2048 sc1 lds
    buffer_load_dwordx4 v214, s[84:87], 0 offen offset:3072 sc1 lds
    s_mov_b32 s42, 1048576
    s_nop 1
L_lw_32:
    ds_read_b128 v[192:195], v253 offset:144
    s_waitcnt lgkmcnt(0)
    v_min_u32 v192, v192, v193
    v_min3_u32 v192, v192, v194, v195
    s_nop 0
    v_readfirstlane_b32 s12, v192
    s_nop 0
    s_cmp_ge_u32 s12, 1
    s_cbranch_scc1 L_lwd_33
    s_sub_u32 s42, s42, 1
    s_cmp_lg_u32 s42, 0
    s_sleep 2
    s_cbranch_scc1 L_lw_32
    s_nop 1
L_lwd_33:
    s_add_u32 s13, s78, 262144
    s_add_u32 m0, s79, 41024
    s_waitcnt vmcnt(10)
    buffer_load_dwordx4 v12, s[80:83], s13 offen lds
    s_add_u32 s13, s78, 311296
    s_add_u32 m0, s79, 43072
    s_waitcnt vmcnt(10)
    buffer_load_dwordx4 v12, s[80:83], s13 offen lds
    s_add_u32 s13, s78, 360448
    s_add_u32 m0, s79, 45120
    s_waitcnt vmcnt(10)
    buffer_load_dwordx4 v12, s[80:83], s13 offen lds
    s_add_u32 s13, s78, 409600
    s_add_u32 m0, s79, 47168
    s_waitcnt vmcnt(10)
    buffer_load_dwordx4 v12, s[80:83], s13 offen lds
    s_add_u32 s13, s78, 458752
    s_add_u32 m0, s79, 49216
    s_waitcnt vmcnt(10)
    buffer_load_dwordx4 v12, s[80:83], s13 offen lds
    s_waitcnt vmcnt(5)
    s_nop 1
L_joinB:
    s_waitcnt lgkmcnt(0)
    v_mov_b32 v250, 2
    ds_write_b32 v23, v250 offset:0
    s_mov_b32 s42, 1048576
    s_nop 1
L_lw_34:
    ds_read_b128 v[192:195], v252 offset:0
    s_waitcnt lgkmcnt(0)
    v_min_u32 v192, v192, v193
    v_min3_u32 v192, v192, v194, v195
    s_nop 0
    v_readfirstlane_b32 s12, v192
    s_nop 0
    s_cmp_ge_u32 s12, 2
    s_cbranch_scc1 L_lwd_35
    s_sub_u32 s42, s42, 1
    s_cmp_lg_u32 s42, 0
    s_sleep 1
    s_cbranch_scc1 L_lw_34
    s_nop 1
L_lwd_35:
    ds_read_b128 v[96:99], v14 offset:0
    ds_read_b64 v[64:65], v13 offset:0
    ds_read_b64 v[66:67], v13 offset:8
    ds_read_b128 v[100:103], v14 offset:1024
    ds_read_b64 v[68:69], v13 offset:512
    ds_read_b64 v[70:71], v13 offset:520
    ds_read_b128 v[104:107], v14 offset:2048
    ds_read_b64 v[72:73], v13 offset:1024
    ds_read_b64 v[74:75], v13 offset:1032
    ds_read_b128 v[108:111], v14 offset:3072
    ds_read_b64 v[76:77], v13 offset:1536
    ds_read_b64 v[78:79], v13 offset:1544
    ds_read_b128 v[112:115], v14 offset:4096
    ds_read_b64 v[80:81], v13 offset:2048
    ds_read_b64 v[82:83], v13 offset:2056
    ds_read_b128 v[116:119], v14 offset:5120
    ds_read_b64 v[84:85], v13 offset:2560
    ds_read_b64 v[86:87], v13 offset:2568
    ds_read_b128 v[120:123], v14 offset:6144
    ds_read_b64 v[88:89], v13 offset:3072
    ds_read_b64 v[90:91], v13 offset:3080
    ds_read_b128 v[124:127], v14 offset:7168
    ds_read_b64 v[92:93], v13 offset:3584
    ds_read_b64 v[94:95], v13 offset:3592
    ds_read_b128 v[160:163], v15 offset:0
    ds_read_b64 v[128:129], v13 offset:64
    ds_read_b64 v[130:131], v13 offset:72
    ds_read_b128 v[164:167], v15 offset:1024
    ds_read_b64 v[132:133], v13 offset:576
    ds_read_b64 v[134:135], v13 offset:584
    ds_read_b128 v[168:171], v15 offset:2048
    ds_read_b64 v[136:137], v13 offset:1088
    ds_read_b64 v[138:139], v13 offset:1096
    ds_read_b128 v[172:175], v15 offset:3072
    ds_read_b64 v[140:141], v13 offset:1600
    ds_read_b64 v[142:143], v13 offset:1608
    ds_read_b128 v[176:179], v15 offset:4096
    ds_read_b64 v[144:145], v13 offset:2112
    ds_read_b64 v[146:147], v13 offset:2120
    ds_read_b128 v[180:183], v15 offset:5120
    ds_read_b64 v[148:149], v13 offset:2624
    ds_read_b64 v[150:151], v13 offset:2632
    ds_read_b128 v[184:187], v15 offset:6144
    ds_read_b64 v[152:153], v13 offset:3136
    ds_read_b64 v[154:155], v13 offset:3144
    ds_read_b128 v[188:191], v15 offset:7168
    ds_read_b64 v[156:157], v13 offset:3648
    ds_read_b64 v[158:159], v13 offset:3656
    s_add_u32 s13, s78, 507904
    s_add_u32 m0, s79, 51264
    s_nop 0
    buffer_load_dwordx4 v12, s[80:83], s13 offen lds
    s_add_u32 s13, s78, 557056
    s_add_u32 m0, s79, 53312
    s_nop 0
    buffer_load_dwordx4 v12, s[80:83], s13 offen lds
    s_add_u32 s13, s78, 606208
    s_add_u32 m0, s79, 55360
    s_nop 0
    buffer_load_dwordx4 v12, s[80:83], s13 offen lds
    s_add_u32 s13, s78, 655360
    s_add_u32 m0, s79, 57408
    s_nop 0
    buffer_load_dwordx4 v12, s[80:83], s13 offen lds
    s_add_u32 s13, s78, 704512
    s_add_u32 m0, s79, 59456
    s_nop 0
    buffer_load_dwordx4 v12, s[80:83], s13 offen lds
    s_getpc_b64 s[12:13]
    s_mov_b32 s14, 4
    s_mov_b32 s15, 0x00020000
    s_lshl2_add_u32 m0, s11, 163728
    s_mov_b64 exec, 1
    buffer_load_dword v215, s[12:15], 0 offen lds
    s_mov_b64 exec, -1
    s_waitcnt vmcnt(10)
    buffer_load_dwordx4 v[24:27], v20, s[68:71], s88 offen
    s_waitcnt vmcnt(10)
    buffer_load_dwordx4 v[28:31], v20, s[68:71], s89 offen
    s_mov_b32 s42, 1048576
    s_nop 1
L_lw_36:
    ds_read_b128 v[192:195], v253 offset:0
    s_waitcnt lgkmcnt(0)
    v_min_u32 v192, v192, v193
    v_min3_u32 v192, v192, v194, v195
    s_nop 0
    v_readfirstlane_b32 s12, v192
    s_nop 0
    s_cmp_ge_u32 s12, 4
    s_cbranch_scc1 L_lwd_37
    s_sub_u32 s42, s42, 1
    s_cmp_lg_u32 s42, 0
    s_sleep 1
    s_cbranch_scc1 L_lw_36
    s_nop 1
L_lwd_37:
    s_setprio 2
    v_mfma_f32_16x16x32_bf16 v[32:35], v[64:67], v[96:99], 0
    v_mfma_f32_16x16x32_bf16 v[36:39], v[68:71], v[96:99], 0
    v_mfma_f32_16x16x32_bf16 v[40:43], v[68:71], v[100:103], 0
    v_mfma_f32_16x16x32_bf16 v[36:39], v[64:67], v[100:103], v[36:39]
    v_mfma_f32_16x16x32_bf16 v[40:43], v[72:75], v[96:99], v[40:43]
    v_mfma_f32_16x16x32_bf16 v[44:47], v[72:75], v[100:103], 0
    v_mfma_f32_16x16x32_bf16 v[48:51], v[72:75], v[104:107], 0
    v_mfma_f32_16x16x32_bf16 v[40:43], v[64:67], v[104:107], v[40:43]
    v_mfma_f32_16x16x32_bf16 v[44:47], v[68:71], v[104:107], v[44:47]
    v_mfma_f32_16x16x32_bf16 v[44:47], v[76:79], v[96:99], v[44:47]
    v_mfma_f32_16x16x32_bf16 v[48:51], v[76:79], v[100:103], v[48:51]
    v_mfma_f32_16x16x32_bf16 v[52:55], v[76:79], v[104:107], 0
    v_mfma_f32_16x16x32_bf16 v[56:59], v[76:79], v[108:111], 0
    v_mfma_f32_16x16x32_bf16 v[44:47], v[64:67], v[108:111], v[44:47]
    v_mfma_f32_16x16x32_bf16 v[48:51], v[68:71], v[108:111], v[48:51]
    v_mfma_f32_16x16x32_bf16 v[52:55], v[72:75], v[108:111], v[52:55]
    v_mfma_f32_16x16x32_bf16 v[48:51], v[80:83], v[96:99], v[48:51]
    v_mfma_f32_16x16x32_bf16 v[52:55], v[80:83], v[100:103], v[52:55]
    v_mfma_f32_16x16x32_bf16 v[56:59], v[80:83], v[104:107], v[56:59]
    v_mfma_f32_16x16x32_bf16 v[60:63], v[80:83], v[108:111], 0
    v_mfma_f32_16x16x32_bf16 v[48:51], v[64:67], v[112:115], v[48:51]
    v_mfma_f32_16x16x32_bf16 v[52:55], v[68:71], v[112:115], v[52:55]
    v_mfma_f32_16x16x32_bf16 v[56:59], v[72:75], v[112:115], v[56:59]
    v_mfma_f32_16x16x32_bf16 v[60:63], v[76:79], v[112:115], v[60:63]
    v_mfma_f32_16x16x32_bf16 v[52:55], v[84:87], v[96:99], v[52:55]
    v_mfma_f32_16x16x32_bf16 v[56:59], v[84:87], v[100:103], v[56:59]
    v_mfma_f32_16x16x32_bf16 v[60:63], v[84:87], v[104:107], v[60:63]
    v_mfma_f32_16x16x32_bf16 v[52:55], v[64:67], v[116:119], v[52:55]
    v_mfma_f32_16x16x32_bf16 v[56:59], v[68:71], v[116:119], v[56:59]
    v_mfma_f32_16x16x32_bf16 v[60:63], v[72:75], v[116:119], v[60:63]
    v_mfma_f32_16x16x32_bf16 v[56:59], v[88:91], v[96:99], v[56:59]
    v_mfma_f32_16x16x32_bf16 v[60:63], v[88:91], v[100:103], v[60:63]
    v_mfma_f32_16x16x32_bf16 v[56:59], v[64:67], v[120:123], v[56:59]
    v_mfma_f32_16x16x32_bf16 v[60:63], v[68:71], v[120:123], v[60:63]
    v_mfma_f32_16x16x32_bf16 v[60:63], v[92:95], v[96:99], v[60:63]
    v_mfma_f32_16x16x32_bf16 v[60:63], v[64:67], v[124:127], v[60:63]
    v_mfma_f32_16x16x32_bf16 v[32:35], v[128:131], v[160:163], v[32:35]
    ds_read_b128 v[96:99], v16 offset:0
    v_mfma_f32_16x16x32_bf16 v[36:39], v[132:135], v[160:163], v[36:39]
    ds_read_b64 v[64:65], v13 offset:128
    v_mfma_f32_16x16x32_bf16 v[40:43], v[132:135], v[164:167], v[40:43]
    ds_read_b64 v[66:67], v13 offset:136
    v_mfma_f32_16x16x32_bf16 v[36:39], v[128:131], v[164:167], v[36:39]
    ds_read_b128 v[100:103], v16 offset:1024
    v_mfma_f32_16x16x32_bf16 v[40:43], v[136:139], v[160:163], v[40:43]
    ds_read_b64 v[68:69], v13 offset:640
    v_mfma_f32_16x16x32_bf16 v[44:47], v[136:139], v[164:167], v[44:47]
    ds_read_b64 v[70:71], v13 offset:648
    v_mfma_f32_16x16x32_bf16 v[48:51], v[136:139], v[168:171], v[48:51]
    ds_read_b128 v[104:107], v16 offset:2048
    v_mfma_f32_16x16x32_bf16 v[40:43], v[128:131], v[168:171], v[40:43]
    ds_read_b64 v[72:73], v13 offset:1152
    v_mfma_f32_16x16x32_bf16 v[44:47], v[132:135], v[168:171], v[44:47]
    ds_read_b64 v[74:75], v13 offset:1160
    v_mfma_f32_16x16x32_bf16 v[44:47], v[140:143], v[160:163], v[44:47]
    ds_read_b128 v[108:111], v16 offset:3072
    v_mfma_f32_16x16x32_bf16 v[48:51], v[140:143], v[164:167], v[48:51]
    ds_read_b64 v[76:77], v13 offset:1664
    v_mfma_f32_16x16x32_bf16 v[52:55], v[140:143], v[168:171], v[52:55]
    ds_read_b64 v[78:79], v13 offset:1672
    v_mfma_f32_16x16x32_bf16 v[56:59], v[140:143], v[172:175], v[56:59]
    ds_read_b128 v[112:115], v16 offset:4096
    v_mfma_f32_16x16x32_bf16 v[44:47], v[128:131], v[172:175], v[44:47]
    ds_read_b64 v[80:81], v13 offset:2176
    v_mfma_f32_16x16x32_bf16 v[48:51], v[132:135], v[172:175], v[48:51]
    ds_read_b64 v[82:83], v13 offset:2184
    v_mfma_f32_16x16x32_bf16 v[52:55], v[136:139], v[172:175], v[52:55]
    ds_read_b128 v[116:119], v16 offset:5120
    v_mfma_f32_16x16x32_bf16 v[48:51], v[144:147], v[160:163], v[48:51]
    ds_read_b64 v[84:85], v13 offset:2688
    v_mfma_f32_16x16x32_bf16 v[52:55], v[144:147], v[164:167], v[52:55]
    ds_read_b64 v[86:87], v13 offset:2696
    v_mfma_f32_16x16x32_bf16 v[56:59], v[144:147], v[168:171], v[56:59]
    ds_read_b128 v[120:123], v16 offset:6144
    v_mfma_f32_16x16x32_bf16 v[60:63], v[144:147], v[172:175], v[60:63]
    ds_read_b64 v[88:89], v13 offset:3200
    v_mfma_f32_16x16x32_bf16 v[48:51], v[128:131], v[176:179], v[48:51]
    ds_read_b64 v[90:91], v13 offset:3208
    v_mfma_f32_16x16x32_bf16 v[52:55], v[132:135], v[176:179], v[52:55]
    ds_read_b128 v[124:127], v16 offset:7168
    v_mfma_f32_16x16x32_bf16 v[56:59], v[136:139], v[176:179], v[56:59]
    ds_read_b64 v[92:93], v13 offset:3712
    v_mfma_f32_16x16x32_bf16 v[60:63], v[140:143], v[176:179], v[60:63]
    ds_read_b64 v[94:95], v13 offset:3720
    v_mfma_f32_16x16x32_bf16 v[52:55], v[148:151], v[160:163], v[52:55]
    v_mfma_f32_16x16x32_bf16 v[56:59], v[148:151], v[164:167], v[56:59]
    v_mfma_f32_16x16x32_bf16 v[60:63], v[148:151], v[168:171], v[60:63]
    v_mfma_f32_16x16x32_bf16 v[52:55], v[128:131], v[180:183], v[52:55]
    v_mfma_f32_16x16x32_bf16 v[56:59], v[132:135], v[180:183], v[56:59]
    v_mfma_f32_16x16x32_bf16 v[60:63], v[136:139], v[180:183], v[60:63]
    v_mfma_f32_16x16x32_bf16 v[56:59], v[152:155], v[160:163], v[56:59]
    v_mfma_f32_16x16x32_bf16 v[60:63], v[152:155], v[164:167], v[60:63]
    v_mfma_f32_16x16x32_bf16 v[56:59], v[128:131], v[184:187], v[56:59]
    v_mfma_f32_16x16x32_bf16 v[60:63], v[132:135], v[184:187], v[60:63]
    v_mfma_f32_16x16x32_bf16 v[60:63], v[156:159], v[160:163], v[60:63]
    v_mfma_f32_16x16x32_bf16 v[60:63], v[128:131], v[188:191], v[60:63]
    s_waitcnt lgkmcnt(15)
    v_mfma_f32_16x16x32_bf16 v[32:35], v[64:67], v[96:99], v[32:35]
    ds_read_b128 v[160:163], v17 offset:0
    v_mfma_f32_16x16x32_bf16 v[36:39], v[68:71], v[96:99], v[36:39]
    ds_read_b64 v[128:129], v13 offset:192
    v_mfma_f32_16x16x32_bf16 v[40:43], v[68:71], v[100:103], v[40:43]
    ds_read_b64 v[130:131], v13 offset:200
    v_mfma_f32_16x16x32_bf16 v[36:39], v[64:67], v[100:103], v[36:39]
    ds_read_b128 v[164:167], v17 offset:1024
    v_mfma_f32_16x16x32_bf16 v[40:43], v[72:75], v[96:99], v[40:43]
    ds_read_b64 v[132:133], v13 offset:704
    v_mfma_f32_16x16x32_bf16 v[44:47], v[72:75], v[100:103], v[44:47]
    ds_read_b64 v[134:135], v13 offset:712
    v_mfma_f32_16x16x32_bf16 v[48:51], v[72:75], v[104:107], v[48:51]
    ds_read_b128 v[168:171], v17 offset:2048
    v_mfma_f32_16x16x32_bf16 v[40:43], v[64:67], v[104:107], v[40:43]
    ds_read_b64 v[136:137], v13 offset:1216
    v_mfma_f32_16x16x32_bf16 v[44:47], v[68:71], v[104:107], v[44:47]
    ds_read_b64 v[138:139], v13 offset:1224
    s_waitcnt lgkmcnt(15)
    v_mfma_f32_16x16x32_bf16 v[44:47], v[76:79], v[96:99], v[44:47]
    ds_read_b128 v[172:175], v17 offset:3072
    v_mfma_f32_16x16x32_bf16 v[48:51], v[76:79], v[100:103], v[48:51]
    ds_read_b64 v[140:141], v13 offset:1728
    v_mfma_f32_16x16x32_bf16 v[52:55], v[76:79], v[104:107], v[52:55]
    ds_read_b64 v[142:143], v13 offset:1736
    v_mfma_f32_16x16x32_bf16 v[56:59], v[76:79], v[108:111], v[56:59]
    ds_read_b128 v[176:179], v17 offset:4096
    v_mfma_f32_16x16x32_bf16 v[44:47], v[64:67], v[108:111], v[44:47]
    ds_read_b64 v[144:145], v13 offset:2240
    v_mfma_f32_16x16x32_bf16 v[48:51], v[68:71], v[108:111], v[48:51]
    ds_read_b64 v[146:147], v13 offset:2248
    v_mfma_f32_16x16x32_bf16 v[52:55], v[72:75], v[108:111], v[52:55]
    ds_read_b128 v[180:183], v17 offset:5120
    v_mfma_f32_16x16x32_bf16 v[48:51], v[80:83], v[96:99], v[48:51]
    ds_read_b64 v[148:149], v13 offset:2752
    v_mfma_f32_16x16x32_bf16 v[52:55], v[80:83], v[100:103], v[52:55]
    ds_read_b64 v[150:151], v13 offset:2760
    v_mfma_f32_16x16x32_bf16 v[56:59], v[80:83], v[104:107], v[56:59]
    ds_read_b128 v[184:187], v17 offset:6144
    v_mfma_f32_16x16x32_bf16 v[60:63], v[80:83], v[108:111], v[60:63]
    ds_read_b64 v[152:153], v13 offset:3264
    v_mfma_f32_16x16x32_bf16 v[48:51], v[64:67], v[112:115], v[48:51]
    ds_read_b64 v[154:155], v13 offset:3272
    v_mfma_f32_16x16x32_bf16 v[52:55], v[68:71], v[112:115], v[52:55]
    ds_read_b128 v[188:191], v17 offset:7168
    v_mfma_f32_16x16x32_bf16 v[56:59], v[72:75], v[112:115], v[56:59]
    ds_read_b64 v[156:157], v13 offset:3776
    v_mfma_f32_16x16x32_bf16 v[60:63], v[76:79], v[112:115], v[60:63]
    ds_read_b64 v[158:159], v13 offset:3784
    v_mfma_f32_16x16x32_bf16 v[52:55], v[84:87], v[96:99], v[52:55]
    v_mfma_f32_16x16x32_bf16 v[56:59], v[84:87], v[100:103], v[56:59]
    v_mfma_f32_16x16x32_bf16 v[60:63], v[84:87], v[104:107], v[60:63]
    v_mfma_f32_16x16x32_bf16 v[52:55], v[64:67], v[116:119], v[52:55]
    v_mfma_f32_16x16x32_bf16 v[56:59], v[68:71], v[116:119], v[56:59]
    v_mfma_f32_16x16x32_bf16 v[60:63], v[72:75], v[116:119], v[60:63]
    s_waitcnt lgkmcnt(15)
    v_mfma_f32_16x16x32_bf16 v[56:59], v[88:91], v[96:99], v[56:59]
    v_mfma_f32_16x16x32_bf16 v[60:63], v[88:91], v[100:103], v[60:63]
    v_mfma_f32_16x16x32_bf16 v[56:59], v[64:67], v[120:123], v[56:59]
    v_mfma_f32_16x16x32_bf16 v[60:63], v[68:71], v[120:123], v[60:63]
    v_mfma_f32_16x16x32_bf16 v[60:63], v[92:95], v[96:99], v[60:63]
    v_mfma_f32_16x16x32_bf16 v[60:63], v[64:67], v[124:127], v[60:63]
    s_waitcnt lgkmcnt(0)
    v_mov_b32 v250, 3
    ds_write_b32 v23, v250 offset:0
    s_lshl_b32 s12, s11, 13
    s_add_u32 s12, s12, 123072
    v_add_u32 v14, s12, v7
    s_lshl_b32 s12, s11, 11
    s_add_u32 s12, s12, 123072
    v_add_u32 v15, s12, v7
    v_mfma_f32_16x16x32_bf16 v[60:63], v[128:131], v[188:191], v[60:63]
    v_mfma_f32_16x16x32_bf16 v[60:63], v[132:135], v[184:187], v[60:63]
    v_mfma_f32_16x16x32_bf16 v[60:63], v[136:139], v[180:183], v[60:63]
    v_mfma_f32_16x16x32_bf16 v[60:63], v[140:143], v[176:179], v[60:63]
    v_mfma_f32_16x16x32_bf16 v[60:63], v[144:147], v[172:175], v[60:63]
    v_mfma_f32_16x16x32_bf16 v[60:63], v[148:151], v[168:171], v[60:63]
    v_mfma_f32_16x16x32_bf16 v[60:63], v[152:155], v[164:167], v[60:63]
    v_mfma_f32_16x16x32_bf16 v[60:63], v[156:159], v[160:163], v[60:63]
    s_mov_b32 s42, 1048576
    s_nop 1
L_lw_38:
    ds_read_b128 v[192:195], v252 offset:0
    s_waitcnt lgkmcnt(0)
    v_min_u32 v192, v192, v193
    v_min3_u32 v192, v192, v194, v195
    s_nop 0
    v_readfirstlane_b32 s12, v192
    s_nop 0
    s_cmp_ge_u32 s12, 3
    s_cbranch_scc1 L_lwd_39
    s_sub_u32 s42, s42, 1
    s_cmp_lg_u32 s42, 0
    s_cbranch_scc1 L_lw_38
    s_nop 1
L_lwd_39:
    v_mfma_f32_16x16x32_bf16 v[56:59], v[128:131], v[184:187], v[56:59]
    v_mfma_f32_16x16x32_bf16 v[56:59], v[132:135], v[180:183], v[56:59]
    v_mfma_f32_16x16x32_bf16 v[56:59], v[136:139], v[176:179], v[56:59]
    v_mfma_f32_16x16x32_bf16 v[56:59], v[140:143], v[172:175], v[56:59]
    v_mfma_f32_16x16x32_bf16 v[56:59], v[144:147], v[168:171], v[56:59]
    v_mfma_f32_16x16x32_bf16 v[56:59], v[148:151], v[164:167], v[56:59]
    v_mfma_f32_16x16x32_bf16 v[56:59], v[152:155], v[160:163], v[56:59]
    ds_write_b128 v14, v[60:63] offset:7168
    v_mfma_f32_16x16x32_bf16 v[52:55], v[128:131], v[180:183], v[52:55]
    v_mfma_f32_16x16x32_bf16 v[52:55], v[132:135], v[176:179], v[52:55]
    v_mfma_f32_16x16x32_bf16 v[52:55], v[136:139], v[172:175], v[52:55]
    v_mfma_f32_16x16x32_bf16 v[52:55], v[140:143], v[168:171], v[52:55]
    v_mfma_f32_16x16x32_bf16 v[52:55], v[144:147], v[164:167], v[52:55]
    v_mfma_f32_16x16x32_bf16 v[52:55], v[148:151], v[160:163], v[52:55]
    s_nop 0
    ds_write_b128 v14, v[56:59] offset:6144
    v_mfma_f32_16x16x32_bf16 v[48:51], v[128:131], v[176:179], v[48:51]
    v_mfma_f32_16x16x32_bf16 v[48:51], v[132:135], v[172:175], v[48:51]
    v_mfma_f32_16x16x32_bf16 v[48:51], v[136:139], v[168:171], v[48:51]
    v_mfma_f32_16x16x32_bf16 v[48:51], v[140:143], v[164:167], v[48:51]
    v_mfma_f32_16x16x32_bf16 v[48:51], v[144:147], v[160:163], v[48:51]
    s_nop 0
    ds_write_b128 v14, v[52:55] offset:5120
    v_mfma_f32_16x16x32_bf16 v[44:47], v[128:131], v[172:175], v[44:47]
    v_mfma_f32_16x16x32_bf16 v[44:47], v[132:135], v[168:171], v[44:47]
    v_mfma_f32_16x16x32_bf16 v[44:47], v[136:139], v[164:167], v[44:47]
    v_mfma_f32_16x16x32_bf16 v[44:47], v[140:143], v[160:163], v[44:47]
    s_nop 1
    ds_write_b128 v14, v[48:51] offset:4096
    v_mfma_f32_16x16x32_bf16 v[40:43], v[128:131], v[168:171], v[40:43]
    v_mfma_f32_16x16x32_bf16 v[40:43], v[132:135], v[164:167], v[40:43]
    v_mfma_f32_16x16x32_bf16 v[40:43], v[136:139], v[160:163], v[40:43]
    s_nop 1
    ds_write_b128 v14, v[44:47] offset:3072
    v_mfma_f32_16x16x32_bf16 v[36:39], v[128:131], v[164:167], v[36:39]
    v_mfma_f32_16x16x32_bf16 v[36:39], v[132:135], v[160:163], v[36:39]
    s_nop 2
    ds_write_b128 v14, v[40:43] offset:2048
    v_mfma_f32_16x16x32_bf16 v[32:35], v[128:131], v[160:163], v[32:35]
    s_nop 2
    ds_write_b128 v14, v[36:39] offset:1024
    s_nop 3
    ds_write_b128 v14, v[32:35]
    s_waitcnt lgkmcnt(0)
    v_mov_b32 v250, 4
    ds_write_b32 v23, v250 offset:0
    v_and_b32 v16, 1, v0
    v_cmp_eq_u32 vcc, 0, v16
    v_bfe_u32 v17, v0, 1, 3
    v_lshrrev_b32 v13, 4, v0
    v_lshlrev_b32 v16, 4, v16
    v_lshl_add_u32 v16, v17, 7, v16
    v_lshl_add_u32 v16, v13, 5, v16
    s_lshl_b32 s12, s2, 13
    s_lshl_b32 s13, s11, 11
    s_add_u32 s12, s12, s13
    s_add_u32 s50, s12, 9830400
    s_mov_b32 s42, 1048576
    s_nop 1
L_lw_40:
    ds_read_b128 v[192:195], v252 offset:0
    s_waitcnt lgkmcnt(0)
    v_min_u32 v192, v192, v193
    v_min3_u32 v192, v192, v194, v195
    s_nop 0
    v_readfirstlane_b32 s12, v192
    s_nop 0
    s_cmp_ge_u32 s12, 4
    s_cbranch_scc1 L_lwd_41
    s_sub_u32 s42, s42, 1
    s_cmp_lg_u32 s42, 0
    s_cbranch_scc1 L_lw_40
    s_nop 1
L_lwd_41:
    ds_read_b128 v[64:67], v15 offset:0
    ds_read_b128 v[80:83], v15 offset:8192
    ds_read_b128 v[96:99], v15 offset:16384
    ds_read_b128 v[112:115], v15 offset:24576
    ds_read_b128 v[68:71], v15 offset:1024
    ds_read_b128 v[84:87], v15 offset:9216
    ds_read_b128 v[100:103], v15 offset:17408
    ds_read_b128 v[116:119], v15 offset:25600
    s_waitcnt lgkmcnt(4)
    v_add_f32 v64, v64, v80
    v_add_f32 v65, v65, v81
    v_add_f32 v66, v66, v82
    v_add_f32 v67, v67, v83
    v_add_f32 v96, v96, v112
    v_add_f32 v97, v97, v113
    v_add_f32 v98, v98, v114
    v_add_f32 v99, v99, v115
    v_cvt_pk_bf16_f32 v128, v64, v96
    v_cvt_pk_bf16_f32 v129, v65, v97
    v_cvt_pk_bf16_f32 v130, v66, v98
    v_cvt_pk_bf16_f32 v131, v67, v99
    v_cndmask_b32 v132, v128, v130, vcc
    v_cndmask_b32 v133, v129, v131, vcc
    v_cndmask_b32 v134, v130, v128, vcc
    v_cndmask_b32 v135, v131, v129, vcc
    v_mov_b32_dpp v128, v132 quad_perm:[1,0,3,2] row_mask:0xf bank_mask:0xf
    v_mov_b32_dpp v129, v133 quad_perm:[1,0,3,2] row_mask:0xf bank_mask:0xf
    v_cndmask_b32 v144, v128, v134, vcc
    v_cndmask_b32 v145, v134, v128, vcc
    v_cndmask_b32 v146, v129, v135, vcc
    v_cndmask_b32 v147, v135, v129, vcc
    buffer_store_dwordx4 v[144:147], v16, s[56:59], s50 offen offset:0 sc1
    s_waitcnt lgkmcnt(0)
    v_mov_b32 v250, 5
    ds_write_b32 v23, v250 offset:0
    v_add_f32 v68, v68, v84
    v_add_f32 v69, v69, v85
    v_add_f32 v70, v70, v86
    v_add_f32 v71, v71, v87
    v_add_f32 v100, v100, v116
    v_add_f32 v101, v101, v117
    v_add_f32 v102, v102, v118
    v_add_f32 v103, v103, v119
    v_cvt_pk_bf16_f32 v136, v68, v100
    v_cvt_pk_bf16_f32 v137, v69, v101
    v_cvt_pk_bf16_f32 v138, v70, v102
    v_cvt_pk_bf16_f32 v139, v71, v103
    v_cndmask_b32 v140, v136, v138, vcc
    v_cndmask_b32 v141, v137, v139, vcc
    v_cndmask_b32 v142, v138, v136, vcc
    v_cndmask_b32 v143, v139, v137, vcc
    v_mov_b32_dpp v136, v140 quad_perm:[1,0,3,2] row_mask:0xf bank_mask:0xf
    v_mov_b32_dpp v137, v141 quad_perm:[1,0,3,2] row_mask:0xf bank_mask:0xf
    v_cndmask_b32 v148, v136, v142, vcc
    v_cndmask_b32 v149, v142, v136, vcc
    v_cndmask_b32 v150, v137, v143, vcc
    v_cndmask_b32 v151, v143, v137, vcc
    buffer_store_dwordx4 v[148:151], v16, s[56:59], s50 offen offset:1024 sc1
    v_lshrrev_b32 v48, 2, v0
    v_and_b32 v49, 3, v0
    v_bfe_u32 v50, v0, 4, 2
    v_xor_b32 v49, v49, v50
    v_lshlrev_b32 v49, 4, v49
    v_lshl_add_u32 v48, v48, 13, v49
    s_lshl_b32 s12, s9, 18
    s_lshl_b32 s13, s8, 8
    s_add_u32 s12, s12, s13
    s_lshl_b32 s13, s11, 6
    s_add_u32 s12, s12, s13
    s_add_u32 s48, s12, 9830400
    s_add_u32 s49, s48, 131072
    s_lshl_b32 s43, s11, 11
    s_add_u32 s43, s43, 123072
    v_lshrrev_b32 v49, 5, v0
    v_and_b32 v50, 3, v0
    v_xor_b32 v49, v49, v50
    v_lshlrev_b32 v49, 4, v49
    v_lshl_add_u32 v49, v19, 8, v49
    v_bfe_u32 v50, v0, 3, 2
    v_lshl_add_u32 v49, v50, 2, v49
    v_add_u32 v49, s43, v49
    v_xor_b32 v50, 32, v49
    v_lshlrev_b32 v52, 1, v19
    v_xor_b32 v52, v52, v18
    v_lshlrev_b32 v52, 4, v52
    v_lshl_add_u32 v52, v18, 8, v52
    s_lshl_b32 s12, s11, 12
    s_add_u32 s12, s12, 41024
    v_add_u32 v52, s12, v52
    v_xor_b32 v53, 16, v52
    s_mov_b32 s60, s36
    s_mov_b32 s61, s37
    s_mov_b32 s62, 2097152
    s_mov_b32 s63, 0x00020000
    s_waitcnt vmcnt(2)
    v_rcp_f32 v202, v201
    s_nop 0
    v_mul_f32 v203, v200, v202
    v_lshlrev_b32 v216, 16, v24
    v_and_b32 v217, 0xffff0000, v24
    v_fma_f32 v232, v216, v202, v203
    v_fma_f32 v233, v217, v202, v203
    v_lshlrev_b32 v218, 16, v25
    v_and_b32 v219, 0xffff0000, v25
    v_fma_f32 v234, v218, v202, v203
    v_fma_f32 v235, v219, v202, v203
    v_lshlrev_b32 v220, 16, v26
    v_and_b32 v221, 0xffff0000, v26
    v_fma_f32 v236, v220, v202, v203
    v_fma_f32 v237, v221, v202, v203
    v_lshlrev_b32 v222, 16, v27
    v_and_b32 v223, 0xffff0000, v27
    v_fma_f32 v238, v222, v202, v203
    v_fma_f32 v239, v223, v202, v203
    v_rcp_f32 v206, v205
    s_nop 0
    v_mul_f32 v207, v204, v206
    v_lshlrev_b32 v224, 16, v28
    v_and_b32 v225, 0xffff0000, v28
    v_fma_f32 v240, v224, v206, v207
    v_fma_f32 v241, v225, v206, v207
    v_lshlrev_b32 v226, 16, v29
    v_and_b32 v227, 0xffff0000, v29
    v_fma_f32 v242, v226, v206, v207
    v_fma_f32 v243, v227, v206, v207
    v_lshlrev_b32 v228, 16, v30
    v_and_b32 v229, 0xffff0000, v30
    v_fma_f32 v244, v228, v206, v207
    v_fma_f32 v245, v229, v206, v207
    v_lshlrev_b32 v230, 16, v31
    v_and_b32 v231, 0xffff0000, v31
    v_fma_f32 v246, v230, v206, v207
    v_fma_f32 v247, v231, v206, v207
    s_waitcnt vmcnt(0)
    s_mov_b64 exec, 1
    buffer_atomic_add v254, v215, s[56:59], s34 offen offset:0 sc1
    s_mov_b64 exec, -1
    s_mov_b32 s42, 1048576
    s_nop 1
L_lw_42:
    ds_read_b128 v[192:195], v252 offset:0
    s_waitcnt lgkmcnt(0)
    v_min_u32 v192, v192, v193
    v_min3_u32 v192, v192, v194, v195
    s_nop 0
    v_readfirstlane_b32 s12, v192
    s_nop 0
    s_cmp_ge_u32 s12, 5
    s_cbranch_scc1 L_lwd_43
    s_sub_u32 s42, s42, 1
    s_cmp_lg_u32 s42, 0
    s_cbranch_scc1 L_lw_42
    s_nop 1
L_lwd_43:
    s_cmp_lg_u32 s11, 0
    s_cbranch_scc1 L_op_44
    s_cmp_lg_u32 s2, 27
    s_cbranch_scc1 L_cld_46
    s_mov_b32 s42, 1048576
    s_mov_b32 s13, 11968512
    v_lshlrev_b32 v37, 7, v0
    s_mov_b32 exec_hi, 0
    s_nop 1
L_cl_45:
    v_mov_b32 v36, 0
    buffer_atomic_add v36, v37, s[56:59], s13 offen sc0 sc1
    s_waitcnt vmcnt(0)
    v_cmp_gt_u32 vcc, 32, v36
    s_sub_u32 s42, s42, 1
    s_cselect_b32 s12, 0, vcc_lo
    s_cmp_lg_u32 s12, 0
    s_cbranch_scc1 L_cl_45
    v_mov_b32 v36, 0
    v_mov_b32 v37, 0
    s_mov_b64 exec, 1
    global_store_dwordx2 v215, v[36:37], s[38:39] sc1
    s_mov_b64 exec, -1
    s_nop 1
L_cld_46:
    s_mov_b32 s42, 1048576
    s_nop 1
L_cw_47:
    v_mov_b32 v34, 0
    s_mov_b64 exec, 1
    buffer_atomic_add v34, v215, s[56:59], s35 offen offset:0 sc0 sc1
    s_mov_b64 exec, -1
    s_waitcnt vmcnt(0)
    v_readfirstlane_b32 s12, v34
    s_nop 0
    s_cmp_ge_u32 s12, 32
    s_cbranch_scc1 L_cwd_48
    s_sub_u32 s42, s42, 1
    s_cmp_lg_u32 s42, 0
    s_sleep 4
    s_cbranch_scc1 L_cw_47
    s_nop 1
L_cwd_48:
    v_mov_b32 v34, 1
    v_mov_b32 v35, 1
    ds_write_b64 v252, v[34:35] offset:160
    s_nop 1
L_op_44:
    s_mov_b32 s42, 1048576
    s_nop 1
L_lw_50:
    ds_read_b64 v[192:193], v252 offset:160
    s_waitcnt lgkmcnt(0)
    v_min_u32 v192, v192, v193
    s_nop 0
    v_readfirstlane_b32 s12, v192
    s_nop 0
    s_cmp_ge_u32 s12, 1
    s_cbranch_scc1 L_lwd_51
    s_sub_u32 s42, s42, 1
    s_cmp_lg_u32 s42, 0
    s_sleep 1
    s_cbranch_scc1 L_lw_50
    s_nop 1
L_lwd_51:
    s_mov_b32 m0, s43
    s_nop 0
    buffer_load_dwordx4 v48, s[56:59], s48 offen sc1 lds
    s_add_u32 m0, s43, 1024
    s_nop 0
    buffer_load_dwordx4 v48, s[56:59], s49 offen sc1 lds
    s_waitcnt vmcnt(0)
    ds_read_b32 v96, v49 offset:0
    ds_read_b32 v97, v49 offset:64
    ds_read_b32 v98, v49 offset:128
    ds_read_b32 v99, v49 offset:192
    ds_read_b32 v100, v50 offset:0
    ds_read_b32 v101, v50 offset:64
    ds_read_b32 v102, v50 offset:128
    ds_read_b32 v103, v50 offset:192
    s_waitcnt lgkmcnt(0)
    v_lshlrev_b32 v104, 16, v96
    v_and_b32 v105, 0xffff0000, v96
    v_fmac_f32 v216, v104, v232
    v_fmac_f32 v217, v105, v233
    v_lshlrev_b32 v104, 16, v97
    v_and_b32 v105, 0xffff0000, v97
    v_fmac_f32 v218, v104, v234
    v_fmac_f32 v219, v105, v235
    v_lshlrev_b32 v104, 16, v98
    v_and_b32 v105, 0xffff0000, v98
    v_fmac_f32 v220, v104, v236
    v_fmac_f32 v221, v105, v237
    v_lshlrev_b32 v104, 16, v99
    v_and_b32 v105, 0xffff0000, v99
    v_fmac_f32 v222, v104, v238
    v_fmac_f32 v223, v105, v239
    v_lshlrev_b32 v104, 16, v100
    v_and_b32 v105, 0xffff0000, v100
    v_fmac_f32 v224, v104, v240
    v_fmac_f32 v225, v105, v241
    v_lshlrev_b32 v104, 16, v101
    v_and_b32 v105, 0xffff0000, v101
    v_fmac_f32 v226, v104, v242
    v_fmac_f32 v227, v105, v243
    v_lshlrev_b32 v104, 16, v102
    v_and_b32 v105, 0xffff0000, v102
    v_fmac_f32 v228, v104, v244
    v_fmac_f32 v229, v105, v245
    v_lshlrev_b32 v104, 16, v103
    v_and_b32 v105, 0xffff0000, v103
    v_fmac_f32 v230, v104, v246
    v_fmac_f32 v231, v105, v247
    s_barrier
    ds_read_b128 v[108:111], v52 offset:0
    ds_read_b128 v[112:115], v53 offset:0
    ds_read_b128 v[124:127], v52 offset:20480
    ds_read_b128 v[128:131], v53 offset:20480
    ds_read_b128 v[116:119], v52 offset:2048
    ds_read_b128 v[120:123], v53 offset:2048
    ds_read_b128 v[132:135], v52 offset:22528
    ds_read_b128 v[136:139], v53 offset:22528
    s_waitcnt lgkmcnt(4)
    v_pk_add_f32 v[108:109], v[108:109], v[124:125]
    v_pk_add_f32 v[108:109], v[108:109], v[216:217]
    v_cvt_pk_bf16_f32 v64, v108, v109
    v_pk_add_f32 v[110:111], v[110:111], v[126:127]
    v_pk_add_f32 v[110:111], v[110:111], v[218:219]
    v_cvt_pk_bf16_f32 v65, v110, v111
    v_pk_add_f32 v[112:113], v[112:113], v[128:129]
    v_pk_add_f32 v[112:113], v[112:113], v[220:221]
    v_cvt_pk_bf16_f32 v66, v112, v113
    v_pk_add_f32 v[114:115], v[114:115], v[130:131]
    v_pk_add_f32 v[114:115], v[114:115], v[222:223]
    v_cvt_pk_bf16_f32 v67, v114, v115
    buffer_store_dwordx4 v[64:67], v20, s[60:63], s88 offen sc1
    s_waitcnt lgkmcnt(0)
    v_pk_add_f32 v[116:117], v[116:117], v[132:133]
    v_pk_add_f32 v[116:117], v[116:117], v[224:225]
    v_cvt_pk_bf16_f32 v68, v116, v117
    v_pk_add_f32 v[118:119], v[118:119], v[134:135]
    v_pk_add_f32 v[118:119], v[118:119], v[226:227]
    v_cvt_pk_bf16_f32 v69, v118, v119
    v_pk_add_f32 v[120:121], v[120:121], v[136:137]
    v_pk_add_f32 v[120:121], v[120:121], v[228:229]
    v_cvt_pk_bf16_f32 v70, v120, v121
    v_pk_add_f32 v[122:123], v[122:123], v[138:139]
    v_pk_add_f32 v[122:123], v[122:123], v[230:231]
    v_cvt_pk_bf16_f32 v71, v122, v123
    buffer_store_dwordx4 v[68:71], v20, s[60:63], s89 offen sc1
    s_nop 1
L_fin:
    s_nop 1
L_end:
    s_endpgm
    s_nop 1
L_idleA:
    s_lshl_b32 s12, s6, 2
    s_lshl_b32 s13, s0, 1
    s_add_u32 s12, s12, s13
    s_mul_i32 s12, s12, 88064
    s_add_u32 s60, s40, s12
    s_addc_u32 s61, s41, 0
    s_mov_b32 s62, 88064
    s_mov_b32 s63, 0x00020000
    s_add_u32 s12, s12, 88064
    s_add_u32 s64, s40, s12
    s_addc_u32 s65, s41, 0
    s_mov_b32 s66, 88064
    s_mov_b32 s67, 0x00020000
    s_lshl_b32 s13, s7, 1
    s_add_u32 s13, s13, s1
    s_mul_i32 s74, s13, 3072
    s_lshl_b32 s12, s6, 1
    s_add_u32 s12, s12, s0
    s_lshl_b32 s12, s12, 8
    s_cmp_ge_u32 s13, 15
    s_cselect_b32 s42, 128, 0
    s_add_u32 s12, s12, s42
    s_add_u32 s75, s12, 11960320
    s_cmp_ge_u32 s13, 30
    s_cselect_b32 s75, 12500992, s75
    s_mov_b32 s68, 0xbdd2d3e8
    s_mov_b32 s69, 0xc0135761
    v_mov_b32 v246, 0
    v_mov_b32 v247, 1
    s_barrier
    s_barrier
    s_mov_b32 s80, s34
    s_mov_b32 s81, s35
    s_mov_b32 s82, 1409024
    s_mov_b32 s83, 0x00020000
    s_lshl2_add_u32 s12, s6, s11
    s_mul_i32 s12, s12, 22016
    v_lshlrev_b32 v245, 7, v0
    buffer_load_dword v244, v245, s[80:83], s12 offen
    s_add_u32 s12, s12, 8192
    buffer_load_dword v244, v245, s[80:83], s12 offen
    s_add_u32 s12, s12, 8192
    s_mov_b32 exec_hi, 0xfff
    buffer_load_dword v244, v245, s[80:83], s12 offen
    s_mov_b32 exec_hi, -1
    v_lshrrev_b32 v32, 5, v0
    v_bfe_u32 v33, v0, 2, 2
    v_lshl_add_u32 v32, v32, 2, v33
    v_lshlrev_b32 v32, 7, v32
    v_bfe_u32 v34, v0, 4, 1
    v_lshl_add_u32 v32, v34, 5, v32
    v_and_b32 v34, 3, v0
    v_lshl_add_u32 v32, v34, 3, v32
    v_bfe_u32 v34, v0, 3, 1
    v_lshl_add_u32 v33, v34, 6, v32
    v_xor_b32 v34, 64, v33
    s_mul_i32 s12, s0, 20480
    v_add_u32 v250, s12, v33
    v_add_u32 v251, s12, v34
    v_add_u32 v248, 82048, v250
    v_add_u32 v249, 82048, v251
    s_lshl_b32 s12, s0, 3
    s_add_u32 s13, s12, 163584
    v_mov_b32 v252, s13
    s_add_u32 s12, s12, 163600
    v_mov_b32 v254, s12
    v_lshrrev_b32 v32, 3, v0
    v_and_b32 v33, 7, v0
    v_bfe_u32 v34, v0, 4, 1
    v_lshlrev_b32 v34, 2, v34
    v_xor_b32 v33, v33, v34
    v_lshlrev_b32 v33, 4, v33
    v_lshl_add_u32 v245, v32, 10, v33
    s_mul_i32 s72, s0, 737280
    s_lshl_b32 s12, s1, 13
    s_add_u32 s72, s72, s12
    s_lshl_b32 s12, s9, 7
    s_add_u32 s72, s72, s12
    s_mul_i32 s73, s0, 20480
    s_lshl_b32 s12, s1, 10
    s_add_u32 s73, s73, s12
    s_lshl_b32 s12, s8, 8
    s_lshl_b32 s13, s0, 7
    s_add_u32 s12, s12, s13
    s_add_u32 s78, s12, 11960320
    s_mul_i32 s79, s0, 46080
    s_lshl_b32 s12, s8, 1
    s_add_u32 s12, s12, s1
    s_mul_i32 s12, s12, 88064
    s_add_u32 s80, s40, s12
    s_addc_u32 s81, s41, 0
    s_mov_b32 s82, 88064
    s_mov_b32 s83, 0x00020000
    s_mov_b32 s84, s34
    s_mov_b32 s85, s35
    s_mov_b32 s86, 1409024
    s_mov_b32 s87, 0x00020000
    v_mov_b32 v57, 0
    v_mov_b32 v59, 0
    v_mov_b32 v2, 4
    ds_write_b32 v253, v2
    ds_write_b32 v253, v2 offset:144
    s_branch L_prefix
    s_nop 1
L_lps_4:
    s_mov_b32 s42, 1048576
    s_nop 1
L_lp_2:
    ds_read_b128 v[4:7], v21
    s_waitcnt lgkmcnt(0)
    v_cmp_eq_u32 vcc, 0, v7
    s_nop 0
    s_cbranch_vccz L_lpd_3
    s_sub_u32 s42, s42, 1
    s_cmp_lg_u32 s42, 0
    s_cbranch_scc1 L_lp_2
    s_branch L_lpd_3
    s_nop 1
L_lps_7:
    s_mov_b32 s42, 1048576
    s_nop 1
L_lp_5:
    ds_read_b64 v[40:41], v1
    ds_read_b64 v[44:45], v1 offset:256
    s_waitcnt lgkmcnt(0)
    v_min_u32 v3, v41, v45
    v_cmp_eq_u32 vcc, 0, v3
    s_nop 0
    s_cbranch_vccz L_lpd_6
    s_sub_u32 s42, s42, 1
    s_cmp_lg_u32 s42, 0
    s_cbranch_scc1 L_lp_5
    s_branch L_lpd_6
    s_nop 1
L_prefix:
    s_mov_b32 s42, 1048576
    s_nop 1
L_lw_52:
    ds_read_b64 v[60:61], v252 offset:128
    s_waitcnt lgkmcnt(0)
    v_min_u32 v60, v60, v61
    s_nop 0
    v_readfirstlane_b32 s12, v60
    s_nop 0
    s_cmp_ge_u32 s12, 1
    s_cbranch_scc1 L_lwd_53
    s_sub_u32 s42, s42, 1
    s_cmp_lg_u32 s42, 0
    s_sleep 1
    s_cbranch_scc1 L_lw_52
    s_nop 1
L_lwd_53:
    s_branch L_prefixed
    s_nop 1
L_fn_17:
    s_mov_b32 s42, 1048576
    s_waitcnt vmcnt(3)
    s_branch L_cwf_56
    s_nop 1
L_cw_54:
    v_mov_b32 v244, 0
    s_mov_b64 exec, 1
    buffer_atomic_add v244, v246, s[56:59], s78 offen offset:0 sc0 sc1
    s_mov_b64 exec, -1
    s_waitcnt vmcnt(0)
    s_nop 1
L_cwf_56:
    v_readfirstlane_b32 s12, v244
    s_nop 0
    s_bfe_u32 s12, s12, 0x80008
    s_cmp_ge_u32 s12, 15
    s_cbranch_scc1 L_cwd_55
    s_sub_u32 s42, s42, 1
    s_cmp_lg_u32 s42, 0
    s_sleep 4
    s_cbranch_scc1 L_cw_54
    s_nop 1
L_cwd_55:
    s_branch L_fnd_18
    s_nop 1
L_fn_19:
    s_mov_b32 s42, 1048576
    s_waitcnt vmcnt(7)
    s_branch L_cwf_59
    s_nop 1
L_cw_57:
    v_mov_b32 v244, 0
    s_mov_b64 exec, 1
    buffer_atomic_add v244, v246, s[56:59], s78 offen offset:0 sc0 sc1
    s_mov_b64 exec, -1
    s_waitcnt vmcnt(0)
    s_nop 1
L_cwf_59:
    v_readfirstlane_b32 s12, v244
    s_nop 0
    s_bfe_u32 s12, s12, 0x80010
    s_cmp_ge_u32 s12, 15
    s_cbranch_scc1 L_cwd_58
    s_sub_u32 s42, s42, 1
    s_cmp_lg_u32 s42, 0
    s_sleep 4
    s_cbranch_scc1 L_cw_57
    s_nop 1
L_cwd_58:
    s_branch L_fnd_20
    s_nop 1
L_w4_21s:
    s_mov_b32 s42, 1048576
    s_nop 1
L_lw_60:
    ds_read_b64 v[68:69], v252 offset:176
    s_waitcnt lgkmcnt(0)
    v_min_u32 v68, v68, v69
    s_nop 0
    v_readfirstlane_b32 s12, v68
    s_nop 0
    s_cmp_ge_u32 s12, 1
    s_cbranch_scc1 L_lwd_61
    s_sub_u32 s42, s42, 1
    s_cmp_lg_u32 s42, 0
    s_cbranch_scc1 L_lw_60
    s_nop 1
L_lwd_61:
    s_branch L_w4_21
    s_nop 1
L_pp_22s:
    s_mov_b32 s42, 1048576
    s_nop 1
L_lw_62:
    ds_read_b64 v[68:69], v254 offset:0
    s_waitcnt lgkmcnt(0)
    v_min_u32 v68, v68, v69
    s_nop 0
    v_readfirstlane_b32 s12, v68
    s_nop 0
    s_cmp_ge_u32 s12, 7
    s_cbranch_scc1 L_lwd_63
    s_sub_u32 s42, s42, 1
    s_cmp_lg_u32 s42, 0
    s_cbranch_scc1 L_lw_62
    s_nop 1
L_lwd_63:
    s_branch L_pp_22
    s_nop 1
L_idleB:
    s_waitcnt vmcnt(8)
    v_lshlrev_b32 v160, 16, v60
    v_and_b32 v161, 0xffff0000, v60
    v_lshlrev_b32 v162, 16, v61
    v_and_b32 v163, 0xffff0000, v61
    v_lshlrev_b32 v164, 16, v62
    v_and_b32 v165, 0xffff0000, v62
    v_lshlrev_b32 v166, 16, v63
    v_and_b32 v167, 0xffff0000, v63
    v_lshlrev_b32 v168, 16, v64
    v_and_b32 v169, 0xffff0000, v64
    v_lshlrev_b32 v170, 16, v65
    v_and_b32 v171, 0xffff0000, v65
    v_lshlrev_b32 v172, 16, v66
    v_and_b32 v173, 0xffff0000, v66
    v_lshlrev_b32 v174, 16, v67
    v_and_b32 v175, 0xffff0000, v67
    v_add_f32 v176, v160, v161
    v_add_f32 v177, v168, v169
    v_add_f32 v176, v176, v162
    v_add_f32 v177, v177, v170
    v_add_f32 v176, v176, v163
    v_add_f32 v177, v177, v171
    v_add_f32 v176, v176, v164
    v_add_f32 v177, v177, v172
    v_add_f32 v176, v176, v165
    v_add_f32 v177, v177, v173
    v_add_f32 v176, v176, v166
    v_add_f32 v177, v177, v174
    v_add_f32 v176, v176, v167
    v_add_f32 v177, v177, v175
    s_nop 0
    v_add_f32_dpp v176, v176, v176 row_shr:1 row_mask:0xf bank_mask:0xf
    v_add_f32_dpp v177, v177, v177 row_shr:1 row_mask:0xf bank_mask:0xf
    s_nop 0
    v_add_f32_dpp v176, v176, v176 row_shr:2 row_mask:0xf bank_mask:0xf
    v_add_f32_dpp v177, v177, v177 row_shr:2 row_mask:0xf bank_mask:0xf
    s_nop 0
    v_add_f32_dpp v176, v176, v176 row_shr:4 row_mask:0xf bank_mask:0xf
    v_add_f32_dpp v177, v177, v177 row_shr:4 row_mask:0xf bank_mask:0xf
    s_nop 0
    v_add_f32_dpp v176, v176, v176 row_shr:8 row_mask:0xf bank_mask:0xf
    v_add_f32_dpp v177, v177, v177 row_shr:8 row_mask:0xf bank_mask:0xf
    s_nop 0
    v_add_f32_dpp v176, v176, v176 row_bcast:15 row_mask:0xa bank_mask:0xf
    v_add_f32_dpp v177, v177, v177 row_bcast:15 row_mask:0xa bank_mask:0xf
    s_nop 0
    v_add_f32_dpp v176, v176, v176 row_bcast:31 row_mask:0xc bank_mask:0xf
    v_add_f32_dpp v177, v177, v177 row_bcast:31 row_mask:0xc bank_mask:0xf
    v_readlane_b32 s17, v176, 63
    v_readlane_b32 s20, v177, 63
    v_mov_b32 v178, 0x3b000000
    v_mul_f32 v180, s17, v178
    v_mul_f32 v181, s20, v178
    v_sub_f32 v160, v160, v180
    v_sub_f32 v168, v168, v181
    v_sub_f32 v161, v161, v180
    v_sub_f32 v169, v169, v181
    v_sub_f32 v162, v162, v180
    v_sub_f32 v170, v170, v181
    v_sub_f32 v163, v163, v180
    v_sub_f32 v171, v171, v181
    v_sub_f32 v164, v164, v180
    v_sub_f32 v172, v172, v181
    v_sub_f32 v165, v165, v180
    v_sub_f32 v173, v173, v181
    v_sub_f32 v166, v166, v180
    v_sub_f32 v174, v174, v181
    v_sub_f32 v167, v167, v180
    v_sub_f32 v175, v175, v181
    v_mul_f32 v176, v160, v160
    v_mul_f32 v177, v168, v168
    v_fmac_f32 v176, v161, v161
    v_fmac_f32 v177, v169, v169
    v_fmac_f32 v176, v162, v162
    v_fmac_f32 v177, v170, v170
    v_fmac_f32 v176, v163, v163
    v_fmac_f32 v177, v171, v171
    v_fmac_f32 v176, v164, v164
    v_fmac_f32 v177, v172, v172
    v_fmac_f32 v176, v165, v165
    v_fmac_f32 v177, v173, v173
    v_fmac_f32 v176, v166, v166
    v_fmac_f32 v177, v174, v174
    v_fmac_f32 v176, v167, v167
    v_fmac_f32 v177, v175, v175
    s_nop 0
    v_add_f32_dpp v176, v176, v176 row_shr:1 row_mask:0xf bank_mask:0xf
    v_add_f32_dpp v177, v177, v177 row_shr:1 row_mask:0xf bank_mask:0xf
    s_nop 0
    v_add_f32_dpp v176, v176, v176 row_shr:2 row_mask:0xf bank_mask:0xf
    v_add_f32_dpp v177, v177, v177 row_shr:2 row_mask:0xf bank_mask:0xf
    s_nop 0
    v_add_f32_dpp v176, v176, v176 row_shr:4 row_mask:0xf bank_mask:0xf
    v_add_f32_dpp v177, v177, v177 row_shr:4 row_mask:0xf bank_mask:0xf
    s_nop 0
    v_add_f32_dpp v176, v176, v176 row_shr:8 row_mask:0xf bank_mask:0xf
    v_add_f32_dpp v177, v177, v177 row_shr:8 row_mask:0xf bank_mask:0xf
    s_nop 0
    v_add_f32_dpp v176, v176, v176 row_bcast:15 row_mask:0xa bank_mask:0xf
    v_add_f32_dpp v177, v177, v177 row_bcast:15 row_mask:0xa bank_mask:0xf
    s_nop 0
    v_add_f32_dpp v176, v176, v176 row_bcast:31 row_mask:0xc bank_mask:0xf
    v_add_f32_dpp v177, v177, v177 row_bcast:31 row_mask:0xc bank_mask:0xf
    v_readlane_b32 s17, v176, 63
    v_readlane_b32 s20, v177, 63
    v_cmp_eq_u32 vcc, 0, v0
    s_nop 0
    v_mov_b32 v176, s20
    v_mov_b32 v177, s17
    v_cndmask_b32 v176, v176, v177, vcc
    v_cndmask_b32 v180, v181, v180, vcc
    v_mul_f32 v176, v176, v178
    v_cvt_pk_bf16_f32 v176, 0, v176
    v_add_f32 v176, 0x3727c5ac, v176
    v_cvt_pk_bf16_f32 v176, 0, v176
    v_sqrt_f32 v176, v176
    v_cvt_pk_bf16_f32 v180, 0, v180
    v_cvt_pk_bf16_f32 v185, 0, v176
    v_xor_b32 v184, 0x80000000, v180
    s_mov_b32 s42, 1048576
    s_waitcnt vmcnt(7)
    s_branch L_noncef_66
    s_nop 1
L_nonce_64:
    v_mov_b32 v58, 0
    global_load_dwordx2 v[58:59], v58, s[38:39] sc1
    s_waitcnt vmcnt(0)
    s_nop 1
L_noncef_66:
    v_readfirstlane_b32 s76, v58
    v_readfirstlane_b32 s77, v59
    s_nop 0
    s_and_b32 s12, s76, s77
    s_bitcmp1_b32 s12, 0
    s_cbranch_scc1 L_nonced_65
    s_sub_u32 s42, s42, 1
    s_cmp_lg_u32 s42, 0
    s_cbranch_scc1 L_nonce_64
    s_nop 1
L_nonced_65:
    v_mov_b32 v186, s76
    v_mov_b32 v187, s77
    s_lshl_b32 s12, s8, 10
    s_lshl_b32 s13, s9, 7
    s_add_u32 s12, s12, s13
    s_lshl_b32 s13, s11, 5
    s_add_u32 s12, s12, s13
    s_add_u32 s12, s12, 11927552
    s_mov_b64 exec, 3
    buffer_store_dwordx4 v[184:187], v7, s[56:59], s12 offen sc1
    s_mov_b64 exec, -1
    s_waitcnt vmcnt(1)
    ds_read2_b32 v[32:33], v146 offset0:0 offset1:32
    ds_read2_b32 v[34:35], v146 offset0:64 offset1:96
    ds_read2_b32 v[36:37], v146 offset0:128 offset1:160
    ds_read2_b32 v[38:39], v146 offset0:192 offset1:224
    ds_read2_b32 v[40:41], v147 offset0:0 offset1:32
    ds_read2_b32 v[42:43], v147 offset0:64 offset1:96
    ds_read2_b32 v[44:45], v150 offset0:0 offset1:32
    ds_read2_b32 v[46:47], v150 offset0:64 offset1:96
    ds_read2_b32 v[48:49], v150 offset0:128 offset1:160
    ds_read2_b32 v[50:51], v150 offset0:192 offset1:224
    ds_read_b32 v52, v150 offset:1024
    v_lshlrev_b32 v96, 16, v54
    v_lshlrev_b32 v97, 16, v56
    v_and_b32 v98, 0xffff0000, v54
    v_and_b32 v99, 0xffff0000, v56
    v_lshlrev_b32 v100, 16, v55
    v_lshlrev_b32 v101, 16, v57
    v_and_b32 v102, 0xffff0000, v55
    v_and_b32 v103, 0xffff0000, v57
    s_waitcnt lgkmcnt(5)
    v_lshlrev_b32 v70, 16, v32
    v_and_b32 v71, 0xffff0000, v32
    v_lshlrev_b32 v72, 16, v33
    v_and_b32 v73, 0xffff0000, v33
    v_lshlrev_b32 v74, 16, v34
    v_and_b32 v75, 0xffff0000, v34
    v_lshlrev_b32 v76, 16, v35
    v_and_b32 v77, 0xffff0000, v35
    v_lshlrev_b32 v78, 16, v36
    v_and_b32 v79, 0xffff0000, v36
    v_lshlrev_b32 v80, 16, v37
    v_and_b32 v81, 0xffff0000, v37
    v_lshlrev_b32 v82, 16, v38
    v_and_b32 v83, 0xffff0000, v38
    v_lshlrev_b32 v84, 16, v39
    v_and_b32 v85, 0xffff0000, v39
    v_lshlrev_b32 v86, 16, v40
    v_and_b32 v87, 0xffff0000, v40
    v_lshlrev_b32 v88, 16, v41
    v_and_b32 v89, 0xffff0000, v41
    v_lshlrev_b32 v90, 16, v42
    v_and_b32 v91, 0xffff0000, v42
    v_lshlrev_b32 v92, 16, v43
    v_and_b32 v93, 0xffff0000, v43
    v_mul_f32 v104, v70, v102
    v_mul_f32 v105, v71, v103
    v_mul_f32 v106, v72, v102
    v_mul_f32 v107, v73, v103
    v_mul_f32 v108, v74, v102
    v_mul_f32 v109, v75, v103
    v_mul_f32 v110, v76, v102
    v_mul_f32 v111, v77, v103
    v_mul_f32 v112, v78, v102
    v_mul_f32 v113, v79, v103
    v_mul_f32 v114, v80, v102
    v_mul_f32 v115, v81, v103
    v_mul_f32 v116, v82, v102
    v_mul_f32 v117, v83, v103
    v_mul_f32 v118, v84, v102
    v_mul_f32 v119, v85, v103
    v_mul_f32 v120, v86, v102
    v_mul_f32 v121, v87, v103
    v_fmac_f32 v104, v72, v100
    v_fmac_f32 v105, v73, v101
    v_fmac_f32 v106, v74, v100
    v_fmac_f32 v107, v75, v101
    v_fmac_f32 v108, v76, v100
    v_fmac_f32 v109, v77, v101
    v_fmac_f32 v110, v78, v100
    v_fmac_f32 v111, v79, v101
    v_fmac_f32 v112, v80, v100
    v_fmac_f32 v113, v81, v101
    v_fmac_f32 v114, v82, v100
    v_fmac_f32 v115, v83, v101
    v_fmac_f32 v116, v84, v100
    v_fmac_f32 v117, v85, v101
    v_fmac_f32 v118, v86, v100
    v_fmac_f32 v119, v87, v101
    v_fmac_f32 v120, v88, v100
    v_fmac_f32 v121, v89, v101
    v_fmac_f32 v104, v74, v98
    v_fmac_f32 v105, v75, v99
    v_fmac_f32 v106, v76, v98
    v_fmac_f32 v107, v77, v99
    v_fmac_f32 v108, v78, v98
    v_fmac_f32 v109, v79, v99
    v_fmac_f32 v110, v80, v98
    v_fmac_f32 v111, v81, v99
    v_fmac_f32 v112, v82, v98
    v_fmac_f32 v113, v83, v99
    v_fmac_f32 v114, v84, v98
    v_fmac_f32 v115, v85, v99
    v_fmac_f32 v116, v86, v98
    v_fmac_f32 v117, v87, v99
    v_fmac_f32 v118, v88, v98
    v_fmac_f32 v119, v89, v99
    v_fmac_f32 v120, v90, v98
    v_fmac_f32 v121, v91, v99
    v_fmac_f32 v104, v76, v96
    v_fmac_f32 v105, v77, v97
    v_fmac_f32 v106, v78, v96
    v_fmac_f32 v107, v79, v97
    v_fmac_f32 v108, v80, v96
    v_fmac_f32 v109, v81, v97
    v_fmac_f32 v110, v82, v96
    v_fmac_f32 v111, v83, v97
    v_fmac_f32 v112, v84, v96
    v_fmac_f32 v113, v85, v97
    v_fmac_f32 v114, v86, v96
    v_fmac_f32 v115, v87, v97
    v_fmac_f32 v116, v88, v96
    v_fmac_f32 v117, v89, v97
    v_fmac_f32 v118, v90, v96
    v_fmac_f32 v119, v91, v97
    v_fmac_f32 v120, v92, v96
    v_fmac_f32 v121, v93, v97
    s_waitcnt lgkmcnt(0)
    v_lshlrev_b32 v70, 16, v44
    v_and_b32 v71, 0xffff0000, v44
    v_lshlrev_b32 v72, 16, v45
    v_and_b32 v73, 0xffff0000, v45
    v_lshlrev_b32 v74, 16, v46
    v_and_b32 v75, 0xffff0000, v46
    v_lshlrev_b32 v76, 16, v47
    v_and_b32 v77, 0xffff0000, v47
    v_lshlrev_b32 v78, 16, v48
    v_and_b32 v79, 0xffff0000, v48
    v_lshlrev_b32 v80, 16, v49
    v_and_b32 v81, 0xffff0000, v49
    v_lshlrev_b32 v82, 16, v50
    v_and_b32 v83, 0xffff0000, v50
    v_lshlrev_b32 v84, 16, v51
    v_and_b32 v85, 0xffff0000, v51
    v_lshlrev_b32 v86, 16, v52
    v_and_b32 v87, 0xffff0000, v52
    v_mul_f32 v104, v104, v70
    v_mul_f32 v105, v105, v71
    v_mul_f32 v106, v106, v72
    v_mul_f32 v107, v107, v73
    v_mul_f32 v108, v108, v74
    v_mul_f32 v109, v109, v75
    v_mul_f32 v110, v110, v76
    v_mul_f32 v111, v111, v77
    v_mul_f32 v112, v112, v78
    v_mul_f32 v113, v113, v79
    v_mul_f32 v114, v114, v80
    v_mul_f32 v115, v115, v81
    v_mul_f32 v116, v116, v82
    v_mul_f32 v117, v117, v83
    v_mul_f32 v118, v118, v84
    v_mul_f32 v119, v119, v85
    v_mul_f32 v120, v120, v86
    v_mul_f32 v121, v121, v87
    v_cvt_pk_bf16_f32 v124, v118, v116
    v_cvt_pk_bf16_f32 v125, v114, v112
    v_cvt_pk_bf16_f32 v126, v110, v108
    v_cvt_pk_bf16_f32 v127, v106, v104
    v_cvt_pk_bf16_f32 v128, v120, v118
    v_cvt_pk_bf16_f32 v129, v116, v114
    v_cvt_pk_bf16_f32 v130, v112, v110
    v_cvt_pk_bf16_f32 v131, v108, v106
    v_cvt_pk_bf16_f32 v132, v119, v117
    v_cvt_pk_bf16_f32 v133, v115, v113
    v_cvt_pk_bf16_f32 v134, v111, v109
    v_cvt_pk_bf16_f32 v135, v107, v105
    v_cvt_pk_bf16_f32 v136, v121, v119
    v_cvt_pk_bf16_f32 v137, v117, v115
    v_cvt_pk_bf16_f32 v138, v113, v111
    v_cvt_pk_bf16_f32 v139, v109, v107
    ds_write_b128 v152, v[124:127] offset:0
    ds_write_b128 v152, v[128:131] offset:16
    ds_write_b128 v152, v[132:135] offset:256
    ds_write_b128 v152, v[136:139] offset:272
    s_waitcnt lgkmcnt(0)
    v_mov_b32 v250, 1
    ds_write_b32 v23, v250 offset:64
    s_mov_b32 s42, 1048576
    s_nop 1
L_lw_67:
    ds_read_b128 v[192:195], v252 offset:64
    s_waitcnt lgkmcnt(0)
    v_min_u32 v192, v192, v193
    v_min3_u32 v192, v192, v194, v195
    s_nop 0
    v_readfirstlane_b32 s12, v192
    s_nop 0
    s_cmp_ge_u32 s12, 1
    s_cbranch_scc1 L_lwd_68
    s_sub_u32 s42, s42, 1
    s_cmp_lg_u32 s42, 0
    s_cbranch_scc1 L_lw_67
    s_nop 1
L_lwd_68:
    ds_read_b128 v[124:127], v153 offset:0
    ds_read_b128 v[128:131], v153 offset:1024
    ds_read_b128 v[132:135], v153 offset:2048
    ds_read_b128 v[136:139], v153 offset:3072
    s_waitcnt lgkmcnt(3)
    s_add_u32 s13, s16, 0
    buffer_store_dwordx4 v[124:127], v154, s[56:59], s13 offen sc1
    s_waitcnt lgkmcnt(2)
    s_add_u32 s13, s16, 32768
    buffer_store_dwordx4 v[128:131], v155, s[56:59], s13 offen sc1
    s_waitcnt lgkmcnt(1)
    s_add_u32 s13, s16, 65536
    buffer_store_dwordx4 v[132:135], v156, s[56:59], s13 offen sc1
    s_waitcnt lgkmcnt(0)
    s_add_u32 s13, s16, 98304
    buffer_store_dwordx4 v[136:139], v157, s[56:59], s13 offen sc1
    s_waitcnt lgkmcnt(0)
    v_mov_b32 v250, 2
    ds_write_b32 v23, v250 offset:64
    s_lshl_b32 s12, s9, 2
    s_add_u32 s12, s12, s11
    s_lshl_b32 s12, s12, 7
    s_add_u32 s13, s12, 11968512
    s_waitcnt vmcnt(0)
    s_mov_b64 exec, 1
    buffer_atomic_add v254, v215, s[56:59], s13 offen offset:0 sc1
    s_mov_b64 exec, -1
    s_mov_b32 s42, 1048576
    s_nop 1
L_lw_69:
    ds_read_b128 v[192:195], v252 offset:64
    s_waitcnt lgkmcnt(0)
    v_min_u32 v192, v192, v193
    v_min3_u32 v192, v192, v194, v195
    s_nop 0
    v_readfirstlane_b32 s12, v192
    s_nop 0
    s_cmp_ge_u32 s12, 2
    s_cbranch_scc1 L_lwd_70
    s_sub_u32 s42, s42, 1
    s_cmp_lg_u32 s42, 0
    s_cbranch_scc1 L_lw_69
    s_nop 1
L_lwd_70:
    s_mov_b32 m0, s33
    s_nop 0
    buffer_load_dwordx4 v7, s[28:31], 0 offen offset:0 lds
    buffer_load_dwordx4 v7, s[28:31], 0 offen offset:1024 lds
    buffer_load_dwordx4 v7, s[28:31], 0 offen offset:2048 lds
    buffer_load_dwordx4 v7, s[28:31], 0 offen offset:3072 lds
    global_load_ushort v8, v8, s[26:27]
    s_add_u32 s42, s2, 3
    s_and_b32 s42, s42, 7
    s_lshl3_add_u32 s42, s5, s42
    s_lshl2_add_u32 s42, s42, s11
    s_lshl_b32 s42, s42, 11
    s_mov_b32 s12, s24
    s_mov_b32 s13, s25
    s_mov_b32 s14, 0x200000
    s_mov_b32 s15, 0x00020000
    v_lshlrev_b32 v249, 7, v0
    s_mov_b64 exec, 0xffff
    buffer_load_dword v248, v249, s[12:15], s42 offen
    s_mov_b64 exec, -1
    s_mul_i32 s12, s1, 4224
    s_add_u32 m0, s12, s43
    s_lshr_b32 exec_lo, 0xffff, s1
    s_mov_b32 exec_hi, 0
    s_mov_b32 s13, 12500992
    buffer_load_dword v215, s[56:59], s13 offen lds
    s_lshl_b32 s12, s1, 9
    s_add_u32 s12, s12, s43
    s_mov_b32 exec_lo, -1
    s_add_u32 m0, s12, 8448
    s_nop 0
    buffer_load_dwordx4 v215, s[56:59], s13 offen lds
    s_mov_b64 exec, -1
    s_add_u32 s13, s78, 0
    s_add_u32 m0, s79, 82048
    s_nop 0
    buffer_load_dwordx4 v12, s[80:83], s13 offen lds
    s_add_u32 s13, s78, 49152
    s_add_u32 m0, s79, 84096
    s_nop 0
    buffer_load_dwordx4 v12, s[80:83], s13 offen lds
    s_add_u32 s13, s78, 98304
    s_add_u32 m0, s79, 86144
    s_nop 0
    buffer_load_dwordx4 v12, s[80:83], s13 offen lds
    s_add_u32 s13, s78, 147456
    s_add_u32 m0, s79, 88192
    s_nop 0
    buffer_load_dwordx4 v12, s[80:83], s13 offen lds
    s_add_u32 s13, s78, 196608
    s_add_u32 m0, s79, 90240
    s_nop 0
    buffer_load_dwordx4 v12, s[80:83], s13 offen lds
    s_add_u32 s13, s78, 245760
    s_add_u32 m0, s79, 92288
    s_nop 0
    buffer_load_dwordx4 v12, s[80:83], s13 offen lds
    s_add_u32 s13, s78, 294912
    s_add_u32 m0, s79, 94336
    s_nop 0
    buffer_load_dwordx4 v12, s[80:83], s13 offen lds
    s_add_u32 s13, s78, 344064
    s_add_u32 m0, s79, 96384
    s_nop 0
    buffer_load_dwordx4 v12, s[80:83], s13 offen lds
    s_add_u32 s13, s78, 393216
    s_add_u32 m0, s79, 98432
    s_nop 0
    buffer_load_dwordx4 v12, s[80:83], s13 offen lds
    s_add_u32 s13, s78, 442368
    s_add_u32 m0, s79, 100480
    s_nop 0
    buffer_load_dwordx4 v12, s[80:83], s13 offen lds
    s_add_u32 s13, s78, 491520
    s_add_u32 m0, s79, 0
    s_nop 0
    buffer_load_dwordx4 v12, s[80:83], s13 offen lds
    s_add_u32 s13, s78, 540672
    s_add_u32 m0, s79, 2048
    s_nop 0
    buffer_load_dwordx4 v12, s[80:83], s13 offen lds
    s_add_u32 s13, s78, 589824
    s_add_u32 m0, s79, 4096
    s_nop 0
    buffer_load_dwordx4 v12, s[80:83], s13 offen lds
    s_add_u32 s13, s78, 638976
    s_add_u32 m0, s79, 6144
    s_nop 0
    buffer_load_dwordx4 v12, s[80:83], s13 offen lds
    s_add_u32 s13, s78, 688128
    s_add_u32 m0, s79, 8192
    s_nop 0
    buffer_load_dwordx4 v12, s[80:83], s13 offen lds
    s_add_u32 s13, s78, 16384
    s_add_u32 m0, s79, 10240
    s_nop 0
    buffer_load_dwordx4 v12, s[80:83], s13 offen lds
    s_add_u32 s13, s78, 65536
    s_add_u32 m0, s79, 12288
    s_nop 0
    buffer_load_dwordx4 v12, s[80:83], s13 offen lds
    s_add_u32 s13, s78, 114688
    s_add_u32 m0, s79, 14336
    s_nop 0
    buffer_load_dwordx4 v12, s[80:83], s13 offen lds
    s_add_u32 s13, s78, 163840
    s_add_u32 m0, s79, 16384
    s_nop 0
    buffer_load_dwordx4 v12, s[80:83], s13 offen lds
    s_add_u32 s13, s78, 212992
    s_add_u32 m0, s79, 18432
    s_nop 0
    buffer_load_dwordx4 v12, s[80:83], s13 offen lds
    s_add_u32 s13, s78, 262144
    s_add_u32 m0, s79, 41024
    s_nop 0
    buffer_load_dwordx4 v12, s[80:83], s13 offen lds
    s_add_u32 s13, s78, 311296
    s_add_u32 m0, s79, 43072
    s_nop 0
    buffer_load_dwordx4 v12, s[80:83], s13 offen lds
    s_add_u32 s13, s78, 360448
    s_add_u32 m0, s79, 45120
    s_nop 0
    buffer_load_dwordx4 v12, s[80:83], s13 offen lds
    s_add_u32 s13, s78, 409600
    s_add_u32 m0, s79, 47168
    s_nop 0
    buffer_load_dwordx4 v12, s[80:83], s13 offen lds
    s_add_u32 s13, s78, 458752
    s_add_u32 m0, s79, 49216
    s_nop 0
    buffer_load_dwordx4 v12, s[80:83], s13 offen lds
    s_getpc_b64 s[12:13]
    s_mov_b32 s14, 4
    s_mov_b32 s15, 0x00020000
    s_lshl2_add_u32 m0, s11, 163696
    s_mov_b64 exec, 1
    buffer_load_dword v215, s[12:15], 0 offen lds
    s_mov_b64 exec, -1
    s_getpc_b64 s[12:13]
    s_mov_b32 s14, 4
    s_mov_b32 s15, 0x00020000
    s_lshl2_add_u32 m0, s11, 163712
    s_mov_b64 exec, 1
    buffer_load_dword v215, s[12:15], 0 offen lds
    s_mov_b64 exec, -1
    s_waitcnt vmcnt(27)
    ds_read_u16 v210, v9
    s_waitcnt lgkmcnt(0)
    v_lshlrev_b32 v210, 16, v210
    v_lshlrev_b32 v8, 16, v8
    v_add_f32 v8, v8, v210
    v_cvt_pk_bf16_f32 v8, v8, 0
    ds_write_b16 v9, v8
    s_mov_b32 s42, 1048576
    s_nop 1
L_cw_71:
    v_mov_b32 v208, 0
    s_mov_b64 exec, 1
    buffer_atomic_add v208, v215, s[56:59], s19 offen offset:0 sc0 sc1
    s_mov_b64 exec, -1
    s_waitcnt vmcnt(0)
    v_readfirstlane_b32 s12, v208
    s_nop 0
    s_cmp_ge_u32 s12, 32
    s_cbranch_scc1 L_cwd_72
    s_sub_u32 s42, s42, 1
    s_cmp_lg_u32 s42, 0
    s_sleep 4
    s_cbranch_scc1 L_cw_71
    s_nop 1
L_cwd_72:
    s_mov_b32 m0, s72
    s_nop 0
    buffer_load_dwordx4 v214, s[84:87], 0 offen offset:0 sc1 lds
    buffer_load_dwordx4 v214, s[84:87], 0 offen offset:1024 sc1 lds
    buffer_load_dwordx4 v214, s[84:87], 0 offen offset:2048 sc1 lds
    buffer_load_dwordx4 v214, s[84:87], 0 offen offset:3072 sc1 lds
    buffer_load_dwordx4 v[200:203], v21, s[56:59], s18 offen sc1
    buffer_load_dwordx4 v[204:207], v21, s[56:59], s18 offen offset:128 sc1
    buffer_load_dwordx4 v[196:199], v10, s[56:59], s32 offen sc1
    s_mov_b32 s42, 1048576
    s_waitcnt vmcnt(0)
    s_branch L_pfirst_76
    s_nop 1
L_poll_74:
    buffer_load_dwordx4 v[200:203], v21, s[56:59], s18 offen sc1
    buffer_load_dwordx4 v[204:207], v21, s[56:59], s18 offen offset:128 sc1
    buffer_load_dwordx4 v[196:199], v10, s[56:59], s32 offen sc1
    s_waitcnt vmcnt(0)
    s_nop 1
L_pfirst_76:
    v_cmp_ne_u64 vcc, s[76:77], v[202:203]
    s_nop 0
    s_mov_b64 s[12:13], vcc
    v_cmp_ne_u64 vcc, s[76:77], v[206:207]
    s_nop 0
    s_or_b64 s[12:13], s[12:13], vcc
    v_cmp_ne_u64 vcc, s[76:77], v[198:199]
    s_nop 0
    s_or_b64 s[12:13], s[12:13], vcc
    s_cmp_eq_u64 s[12:13], 0
    s_cbranch_scc1 L_pdone_75
    s_sub_u32 s42, s42, 1
    s_cmp_lg_u32 s42, 0
    s_sleep 4
    s_cbranch_scc1 L_poll_74
    s_nop 1
L_pdone_75:
    s_waitcnt vmcnt(0)
    s_branch L_joinB
L_code_end:
.section .rodata,"a"
.p2align 6
.amdhsa_kernel parallel_sum__ssm_conv_h3__geglu_ffn__prompt_kernel
  .amdhsa_next_free_vgpr 256
  .amdhsa_next_free_sgpr 102
  .amdhsa_accum_offset 256
  .amdhsa_group_segment_fixed_size 0
  .amdhsa_kernarg_size 104
  .amdhsa_user_sgpr_count 2
  .amdhsa_user_sgpr_kernarg_segment_ptr 1
  .amdhsa_system_sgpr_workgroup_id_x 1
.end_amdhsa_kernel
```
